```python
import torch

def _softmax(x, axis=-1):
    return torch.softmax(x, dim=axis)
def _gelu(x):
    return torch.nn.functional.gelu(x, approximate="tanh")
def _silu(x):
    return torch.nn.functional.silu(x)
def _sigmoid(x):
    return torch.sigmoid(x)
def _layernorm(x, axis=-1, eps=1e-5):
    m = x.mean(dim=axis, keepdim=True)
    v = x.var(dim=axis, keepdim=True, unbiased=False)
    return (x - m) / torch.sqrt(v + eps)
def _scatter_add(tgt, idx, src, axis=0):
    return tgt.clone().index_add_(axis, idx, src)
def _segment_sum(src, seg, n):
    out = torch.zeros((n,) + src.shape[1:], dtype=src.dtype)
    return out.index_add_(0, seg, src)
def _pad(x, pw):
    flat = tuple(v for pair in reversed(pw) for v in pair)
    return torch.nn.functional.pad(x, flat)

kernel_name = 'sequential_preLN__mha_block_cached__glu_gated_bilinear__decode'

def setup_inputs():

    _w = (lambda a: (lambda t: t.to(torch.bfloat16) if t.is_floating_point() else t)(torch.as_tensor(a)))
    def _A_setup():
        B, Sq, D = 4, 1, 448
        H, Sk, Dh = 16, 8192, 256
        return {
            "x": _w((lambda *s: torch.randn(*s, dtype=torch.bfloat16) * 0.05)(B, Sq, D)),
            "k_cache": _w((lambda *s: torch.randn(*s, dtype=torch.bfloat16) * 1.6)(B, H, Sk, Dh)),
            "v_cache": _w((lambda *s: torch.randn(*s, dtype=torch.bfloat16) * 0.8)(B, H, Sk, Dh)),
            "wq": _w((lambda *s: torch.randn(*s, dtype=torch.bfloat16) * 1.6)(D, H * Dh) * (D ** -0.5)),
            "wo": _w((lambda *s: torch.randn(*s, dtype=torch.bfloat16) * 0.8)(H * Dh, D) * ((H * Dh) ** -0.5)),
        }
    _A_in = _A_setup()

    def _B_setup():
        B, S, D, F = 4, 1, 448, 1792
        return {
            "x": _w((lambda *s: torch.randn(*s, dtype=torch.bfloat16) * 0.05)(B, S, D)),
            "w_gate": _w((lambda *s: torch.randn(*s, dtype=torch.bfloat16) * 0.4)(D, F) * (D ** -0.5)),
            "w_up": _w((lambda *s: torch.randn(*s, dtype=torch.bfloat16) * 0.4)(D, F) * (D ** -0.5)),
            "w_down": _w((lambda *s: torch.randn(*s, dtype=torch.bfloat16) * 0.4)(F, D) * (F ** -0.5)),
        }
    _B_in = _B_setup()

    return {
        "A_x": _A_in["x"],
        "A_k_cache": _A_in["k_cache"],
        "A_v_cache": _A_in["v_cache"],
        "A_wq": _A_in["wq"],
        "A_wo": _A_in["wo"],
        "B_x": _B_in["x"],
        "B_w_gate": _B_in["w_gate"],
        "B_w_up": _B_in["w_up"],
        "B_w_down": _B_in["w_down"],
    }

def reference(A_x, A_k_cache, A_v_cache, A_wq, A_wo, B_x, B_w_gate, B_w_up, B_w_down):
    def _A_ref(x, k_cache, v_cache, wq, wo):
        B, Sq, D = x.shape
        H, Dh = 16, 256
        q = (lambda x, *d: x.permute(*d))((x @ wq).reshape(B, Sq, H, Dh), 0, 2, 1, 3)
        scores = torch.einsum("bhqd,bhkd->bhqk", q, k_cache) * (Dh ** -0.5)
        p = _softmax(scores, axis=-1)
        o = torch.einsum("bhqk,bhkd->bhqd", p, v_cache)
        return (lambda x, *d: x.permute(*d))(o, 0, 2, 1, 3).reshape(B, Sq, H * Dh) @ wo

    def _B_ref(x, w_gate, w_up, w_down):
        g = torch.einsum("bsd,df->bsf", x, w_gate)
        u = torch.einsum("bsd,df->bsf", x, w_up)
        h = g * u
        return torch.einsum("bsf,fd->bsd", h, w_down)

    x = A_x
    h = x + _A_ref(_layernorm(x, axis=-1), A_k_cache, A_v_cache, A_wq, A_wo)
    h2 = h + _B_ref(_layernorm(h, axis=-1), B_w_gate, B_w_up, B_w_down)
    return h2
```

```asm
; @launch grid=(256,1,1) block=(512,1,1) lds=159232
.amdgcn_target "amdgcn-amd-amdhsa--gfx950"
.text
.globl sequential_preLN__mha_block_cached__glu_gated_bilinear__decode_kernel
.p2align 8
.type sequential_preLN__mha_block_cached__glu_gated_bilinear__decode_kernel,@function
sequential_preLN__mha_block_cached__glu_gated_bilinear__decode_kernel:
    s_cmp_ge_u32 s2, 256
    s_cbranch_scc1 L_exit
    s_load_dwordx16 s[4:19], s[0:1], 0
    s_load_dwordx8 s[20:27], s[0:1], 64
    v_lshrrev_b32 v1, 6, v0
    v_and_b32 v0, 63, v0
    v_readfirstlane_b32 s3, v1
    s_and_b32 s48, s2, 5
    s_lshl_b32 s48, s48, 1
    s_lshr_b32 s49, s2, 1
    s_and_b32 s49, s49, 5
    s_or_b32 s48, s48, s49
    s_and_b32 s29, s48, 3
    s_and_b32 s49, s2, 0x30
    s_or_b32 s28, s48, s49
    s_lshr_b32 s28, s28, 2
    s_lshr_b32 s30, s2, 6
    s_lshl_b32 s31, s30, 4
    s_add_u32 s31, s31, s28
    v_and_b32 v1, 15, v0
    v_lshrrev_b32 v2, 4, v0
    v_lshrrev_b32 v3, 5, v0
    s_cmp_lg_u32 s3, 0
    s_cbranch_scc1 L_worker
L_loader:
    s_setprio 3
    v_and_b32 v4, 31, v0
    v_xor_b32 v4, v4, v3
    v_lshlrev_b32 v4, 4, v4
    v_lshl_add_u32 v8, v3, 9, v4
    v_xor_b32 v9, 32, v8
    v_xor_b32 v10, 64, v8
    v_xor_b32 v11, 96, v8
    v_xor_b32 v12, 128, v8
    v_xor_b32 v13, 160, v8
    v_xor_b32 v14, 192, v8
    v_xor_b32 v15, 224, v8
    s_lshl_b32 s59, s31, 22
    s_lshl_b32 s49, s29, 20
    s_add_u32 s59, s59, s49
    s_mov_b32 s56, 0
    s_mov_b32 s58, 0
    s_mov_b32 m0, 0
    s_mov_b32 s60, 0
    s_mov_b32 s57, s60
    s_mov_b32 s34, 1048576
    s_mov_b32 s35, 0x20000
    v_mov_b32 v24, 131072
    v_mov_b32 v17, 131076
    s_mov_b32 s50, 0
    v_mov_b32 v20, 0
    v_mov_b32 v21, 0
    v_mov_b32 v22, 0
    v_mov_b32 v23, 0
    ds_write_b128 v24, v[20:23]
    ds_write_b128 v24, v[20:23] offset:16
    ds_write_b128 v24, v[20:23] offset:32
    s_waitcnt lgkmcnt(0)
    s_add_u32 s32, s6, s59
    s_addc_u32 s33, s7, 0
    s_and_b32 s33, s33, 0xffff
L_lramp:
    s_waitcnt vmcnt(21)
    buffer_load_dwordx4 v8, s[32:35], s57 offen offset:0 nt lds
    s_waitcnt vmcnt(21)
    buffer_load_dwordx4 v9, s[32:35], s57 offen offset:1024 nt lds
    s_waitcnt vmcnt(21)
    buffer_load_dwordx4 v10, s[32:35], s57 offen offset:2048 nt lds
    s_waitcnt vmcnt(21)
    buffer_load_dwordx4 v11, s[32:35], s57 offen offset:3072 nt lds
    s_add_u32 m0, s56, 4096
    s_add_u32 s57, s57, 4096
    s_waitcnt vmcnt(21)
    buffer_load_dwordx4 v12, s[32:35], s57 offen offset:0 nt lds
    s_waitcnt vmcnt(21)
    buffer_load_dwordx4 v13, s[32:35], s57 offen offset:1024 nt lds
    s_waitcnt vmcnt(21)
    buffer_load_dwordx4 v14, s[32:35], s57 offen offset:2048 nt lds
    s_waitcnt vmcnt(21)
    buffer_load_dwordx4 v15, s[32:35], s57 offen offset:3072 nt lds
    s_cmp_lg_u32 s58, 0
    s_cbranch_scc1 L_lnb
    s_barrier
L_lnb:
    s_branch L_lnext
L_ld0:
    s_waitcnt vmcnt(21)
    buffer_load_dwordx4 v8, s[32:35], s57 offen offset:0 nt lds
    s_waitcnt vmcnt(21)
    buffer_load_dwordx4 v9, s[32:35], s57 offen offset:1024 nt lds
    s_waitcnt vmcnt(21)
    buffer_load_dwordx4 v10, s[32:35], s57 offen offset:2048 nt lds
    s_waitcnt vmcnt(21)
    buffer_load_dwordx4 v11, s[32:35], s57 offen offset:3072 nt lds
    ds_read_b32 v25, v24 offset:28
    s_add_u32 m0, s56, 4096
    s_add_u32 s57, s57, 4096
    s_waitcnt vmcnt(21)
    buffer_load_dwordx4 v12, s[32:35], s57 offen offset:0 nt lds
    s_sub_u32 s49, s58, 2
    s_max_i32 s49, s49, 0
    v_mov_b32 v19, s49
    s_waitcnt vmcnt(21)
    buffer_load_dwordx4 v13, s[32:35], s57 offen offset:1024 nt lds
    ds_write_b32 v24, v19
    s_waitcnt vmcnt(21)
    buffer_load_dwordx4 v14, s[32:35], s57 offen offset:2048 nt lds
    s_waitcnt vmcnt(21)
    buffer_load_dwordx4 v15, s[32:35], s57 offen offset:3072 nt lds
    s_waitcnt lgkmcnt(0)
    v_readfirstlane_b32 s50, v25
    s_branch L_lnext
L_ld1:
    s_waitcnt vmcnt(17)
    buffer_load_dwordx4 v8, s[32:35], s57 offen offset:0 nt lds
    s_sub_u32 s49, s58, 2
    s_max_i32 s49, s49, 0
    v_mov_b32 v19, s49
    s_waitcnt vmcnt(17)
    buffer_load_dwordx4 v9, s[32:35], s57 offen offset:1024 nt lds
    ds_write_b32 v24, v19
    s_waitcnt vmcnt(17)
    buffer_load_dwordx4 v10, s[32:35], s57 offen offset:2048 nt lds
    s_waitcnt vmcnt(17)
    buffer_load_dwordx4 v11, s[32:35], s57 offen offset:3072 nt lds
    ds_read_b32 v25, v24 offset:28
    s_waitcnt lgkmcnt(0)
    v_readfirstlane_b32 s50, v25
    s_add_u32 m0, s56, 4096
    s_add_u32 s57, s57, 4096
    s_waitcnt vmcnt(17)
    buffer_load_dwordx4 v12, s[32:35], s57 offen offset:0 nt lds
    s_waitcnt vmcnt(17)
    buffer_load_dwordx4 v13, s[32:35], s57 offen offset:1024 nt lds
    s_waitcnt vmcnt(17)
    buffer_load_dwordx4 v14, s[32:35], s57 offen offset:2048 nt lds
    s_waitcnt vmcnt(17)
    buffer_load_dwordx4 v15, s[32:35], s57 offen offset:3072 nt lds
    s_branch L_lnext
L_ld2:
    s_waitcnt vmcnt(19)
    buffer_load_dwordx4 v8, s[32:35], s57 offen offset:0 nt lds
    s_waitcnt vmcnt(19)
    buffer_load_dwordx4 v9, s[32:35], s57 offen offset:1024 nt lds
    s_waitcnt vmcnt(19)
    buffer_load_dwordx4 v10, s[32:35], s57 offen offset:2048 nt lds
    s_sub_u32 s49, s58, 2
    s_max_i32 s49, s49, 0
    v_mov_b32 v19, s49
    s_waitcnt vmcnt(19)
    buffer_load_dwordx4 v11, s[32:35], s57 offen offset:3072 nt lds
    ds_write_b32 v24, v19
    ds_read_b32 v25, v24 offset:28
    s_waitcnt lgkmcnt(0)
    v_readfirstlane_b32 s50, v25
    s_add_u32 m0, s56, 4096
    s_add_u32 s57, s57, 4096
    s_waitcnt vmcnt(19)
    buffer_load_dwordx4 v12, s[32:35], s57 offen offset:0 nt lds
    s_waitcnt vmcnt(19)
    buffer_load_dwordx4 v13, s[32:35], s57 offen offset:1024 nt lds
    s_waitcnt vmcnt(19)
    buffer_load_dwordx4 v14, s[32:35], s57 offen offset:2048 nt lds
    s_waitcnt vmcnt(19)
    buffer_load_dwordx4 v15, s[32:35], s57 offen offset:3072 nt lds
    s_branch L_lnext
L_ld3:
    s_waitcnt vmcnt(23)
    buffer_load_dwordx4 v8, s[32:35], s57 offen offset:0 nt lds
    s_waitcnt vmcnt(23)
    buffer_load_dwordx4 v9, s[32:35], s57 offen offset:1024 nt lds
    s_waitcnt vmcnt(23)
    buffer_load_dwordx4 v10, s[32:35], s57 offen offset:2048 nt lds
    s_waitcnt vmcnt(23)
    buffer_load_dwordx4 v11, s[32:35], s57 offen offset:3072 nt lds
    ds_read_b32 v25, v24 offset:28
    s_add_u32 m0, s56, 4096
    s_add_u32 s57, s57, 4096
    s_waitcnt vmcnt(23)
    buffer_load_dwordx4 v12, s[32:35], s57 offen offset:0 nt lds
    s_waitcnt vmcnt(23)
    buffer_load_dwordx4 v13, s[32:35], s57 offen offset:1024 nt lds
    s_waitcnt vmcnt(23)
    buffer_load_dwordx4 v14, s[32:35], s57 offen offset:2048 nt lds
    s_sub_u32 s49, s58, 2
    s_max_i32 s49, s49, 0
    v_mov_b32 v19, s49
    s_waitcnt vmcnt(23)
    buffer_load_dwordx4 v15, s[32:35], s57 offen offset:3072 nt lds
    ds_write_b32 v24, v19
    s_waitcnt lgkmcnt(0)
    v_readfirstlane_b32 s50, v25
    s_branch L_lnext
L_ld4:
    s_waitcnt vmcnt(26)
    buffer_load_dwordx4 v8, s[32:35], s57 offen offset:0 nt lds
    s_waitcnt vmcnt(26)
    buffer_load_dwordx4 v9, s[32:35], s57 offen offset:1024 nt lds
    s_sub_u32 s49, s58, 3
    s_max_i32 s49, s49, 0
    v_mov_b32 v19, s49
    s_waitcnt vmcnt(26)
    buffer_load_dwordx4 v10, s[32:35], s57 offen offset:2048 nt lds
    ds_write_b32 v24, v19
    s_waitcnt vmcnt(26)
    buffer_load_dwordx4 v11, s[32:35], s57 offen offset:3072 nt lds
    ds_read_b32 v25, v24 offset:28
    s_add_u32 m0, s56, 4096
    s_add_u32 s57, s57, 4096
    s_waitcnt vmcnt(26)
    buffer_load_dwordx4 v12, s[32:35], s57 offen offset:0 nt lds
    s_waitcnt vmcnt(26)
    buffer_load_dwordx4 v13, s[32:35], s57 offen offset:1024 nt lds
    s_waitcnt vmcnt(26)
    buffer_load_dwordx4 v14, s[32:35], s57 offen offset:2048 nt lds
    s_waitcnt vmcnt(26)
    buffer_load_dwordx4 v15, s[32:35], s57 offen offset:3072 nt lds
    s_waitcnt lgkmcnt(0)
    v_readfirstlane_b32 s50, v25
    s_branch L_lnext
L_ld5:
    s_waitcnt vmcnt(31)
    buffer_load_dwordx4 v8, s[32:35], s57 offen offset:0 nt lds
    s_waitcnt vmcnt(31)
    buffer_load_dwordx4 v9, s[32:35], s57 offen offset:1024 nt lds
    s_waitcnt vmcnt(31)
    buffer_load_dwordx4 v10, s[32:35], s57 offen offset:2048 nt lds
    s_waitcnt vmcnt(31)
    buffer_load_dwordx4 v11, s[32:35], s57 offen offset:3072 nt lds
    ds_read_b32 v25, v24 offset:28
    s_add_u32 m0, s56, 4096
    s_add_u32 s57, s57, 4096
    s_waitcnt vmcnt(31)
    buffer_load_dwordx4 v12, s[32:35], s57 offen offset:0 nt lds
    s_waitcnt vmcnt(31)
    buffer_load_dwordx4 v13, s[32:35], s57 offen offset:1024 nt lds
    s_waitcnt vmcnt(31)
    buffer_load_dwordx4 v14, s[32:35], s57 offen offset:2048 nt lds
    s_sub_u32 s49, s58, 3
    s_max_i32 s49, s49, 0
    v_mov_b32 v19, s49
    s_waitcnt vmcnt(31)
    buffer_load_dwordx4 v15, s[32:35], s57 offen offset:3072 nt lds
    ds_write_b32 v24, v19
    s_waitcnt lgkmcnt(0)
    v_readfirstlane_b32 s50, v25
L_lnext:
    s_add_u32 s57, s57, 4096
    s_and_b32 s57, s57, 0xfffff
    s_add_u32 s56, s56, 8192
    s_and_b32 s56, s56, 0x1ffff
    s_add_u32 s58, s58, 1
    s_cmp_lg_u32 s58, 128
    s_cbranch_scc1 L_lnosw
    s_add_u32 s32, s8, s59
    s_addc_u32 s33, s9, 0
    s_and_b32 s33, s33, 0xffff
    s_mov_b32 s57, s60
    v_lshlrev_b32 v8, 4, v0
    v_lshlrev_b32 v9, 4, v0
    v_lshlrev_b32 v10, 4, v0
    v_lshlrev_b32 v11, 4, v0
    v_lshlrev_b32 v12, 4, v0
    v_lshlrev_b32 v13, 4, v0
    v_lshlrev_b32 v14, 4, v0
    v_lshlrev_b32 v15, 4, v0
L_lnosw:
    s_cmp_ge_u32 s58, 254
    s_cbranch_scc1 L_ldrain
    s_mov_b32 m0, s56
    s_cmp_lt_u32 s58, 6
    s_cbranch_scc1 L_lramp
    s_lshr_b32 s49, s58, 1
    s_sub_u32 s49, s49, 7
    s_mov_b32 s63, 1048576
L_fp1:
    ds_read_b32 v18, v17
    s_waitcnt lgkmcnt(0)
    v_readfirstlane_b32 s48, v18
    s_cmp_ge_i32 s48, s49
    s_cbranch_scc1 L_fg2
    s_sleep 1
    s_sub_u32 s63, s63, 1
    s_cbranch_scc0 L_fp1
L_fg2:
    v_xor_b32 v17, 12, v17
    s_mov_b32 m0, s56
    s_cmp_eq_u32 s50, 1
    s_cbranch_scc1 L_ld1
    s_cmp_eq_u32 s50, 2
    s_cbranch_scc1 L_ld2
    s_cmp_eq_u32 s50, 3
    s_cbranch_scc1 L_ld3
    s_cmp_eq_u32 s50, 4
    s_cbranch_scc1 L_ld4
    s_cmp_eq_u32 s50, 5
    s_cbranch_scc1 L_ld5
    s_branch L_ld0
L_ldrain:
    v_mov_b32 v19, 250
    s_waitcnt vmcnt(32)
    ds_write_b32 v24, v19
    v_mov_b32 v19, 251
    s_waitcnt vmcnt(24)
    ds_write_b32 v24, v19
    v_mov_b32 v19, 252
    s_waitcnt vmcnt(16)
    ds_write_b32 v24, v19
    v_mov_b32 v19, 253
    s_waitcnt vmcnt(8)
    ds_write_b32 v24, v19
    v_mov_b32 v19, 254
    s_waitcnt vmcnt(0)
    ds_write_b32 v24, v19
    s_waitcnt lgkmcnt(0)
    s_endpgm
L_worker:
    s_sub_u32 s60, s3, 1
    v_lshlrev_b32 v5, 4, v0
    s_mul_i32 s48, s30, 896
    v_add_u32 v5, s48, v5
    v_mov_b32 v6, 0x7fffff00
    v_cmp_gt_u32 vcc, 56, v0
    v_and_b32 v4, 7, v0
    v_lshlrev_b32 v4, 4, v4
    v_cndmask_b32 v5, v6, v5, vcc
    v_lshrrev_b32 v13, 3, v0
    v_lshl_add_u32 v4, v13, 16, v4
    s_lshl_b32 s48, s60, 19
    s_lshl_b32 s49, s28, 9
    s_add_u32 s48, s48, s49
    s_lshl_b32 s49, s29, 7
    s_add_u32 s48, s48, s49
    v_add_u32 v4, s48, v4
    s_waitcnt lgkmcnt(0)
    s_mov_b32 s32, s4
    s_and_b32 s33, s5, 0xffff
    s_mov_b32 s34, 3584
    s_mov_b32 s35, 0x20000
    s_mov_b32 s36, s10
    s_and_b32 s37, s11, 0xffff
    s_mov_b32 s38, 3670016
    s_mov_b32 s39, 0x20000
    buffer_load_dwordx4 v[40:43], v5, s[32:35], 0 offen
    s_add_u32 s48, s26, 1179648
    s_addc_u32 s49, s27, 0
    s_load_dword s62, s[48:49], 0
    v_mov_b32 v15, 0
    s_barrier
    s_mov_b32 s50, 0
    buffer_load_dwordx4 v[56:59], v4, s[36:39], s50 offen nt
    s_add_u32 s50, s50, 8192
    buffer_load_dwordx4 v[60:63], v4, s[36:39], s50 offen nt
    s_add_u32 s50, s50, 8192
    buffer_load_dwordx4 v[64:67], v4, s[36:39], s50 offen nt
    s_add_u32 s50, s50, 8192
    buffer_load_dwordx4 v[68:71], v4, s[36:39], s50 offen nt
    s_add_u32 s50, s50, 8192
    buffer_load_dwordx4 v[72:75], v4, s[36:39], s50 offen nt
    s_add_u32 s50, s50, 8192
    buffer_load_dwordx4 v[76:79], v4, s[36:39], s50 offen nt
    s_add_u32 s50, s50, 8192
    buffer_load_dwordx4 v[80:83], v4, s[36:39], s50 offen nt
    s_add_u32 s50, s50, 8192
    buffer_load_dwordx4 v[84:87], v4, s[36:39], s50 offen nt
    s_mov_b32 s40, s26
    s_and_b32 s41, s27, 0xffff
    s_mov_b32 s42, 3145728
    s_mov_b32 s43, 0x20000
    v_mov_b32 v36, -1
    v_mov_b32 v37, -1
    v_mov_b32 v38, -1
    v_mov_b32 v39, -1
    s_lshl_b32 s48, s2, 2
    s_add_u32 s48, s48, s3
    s_sub_u32 s48, s48, 4
    s_lshl_b32 s48, s48, 10
    s_cmp_ge_u32 s3, 4
    s_cselect_b32 s48, s48, 3145728
    v_lshlrev_b32 v6, 4, v0
    buffer_store_dwordx4 v[36:39], v6, s[40:43], s48 offen sc1
    v_and_b32 v6, 1, v1
    v_cmp_eq_u32 vcc, 1, v6
    v_mov_b32 v7, 0x0c0c0100
    v_mov_b32 v8, 0x01000c0c
    v_mov_b32 v9, 0x0c0c0302
    v_mov_b32 v10, 0x03020c0c
    v_cndmask_b32 v7, v7, v8, vcc
    v_cndmask_b32 v9, v9, v10, vcc
    v_bfe_u32 v6, v1, 1, 2
    v_mov_b32 v10, 0x0c0c0c0c
    v_cmp_eq_u32 vcc, 0, v6
    s_nop 1
    v_cndmask_b32 v16, v10, v7, vcc
    v_cndmask_b32 v20, v10, v9, vcc
    v_cmp_eq_u32 vcc, 1, v6
    s_nop 1
    v_cndmask_b32 v17, v10, v7, vcc
    v_cndmask_b32 v21, v10, v9, vcc
    v_cmp_eq_u32 vcc, 2, v6
    s_nop 1
    v_cndmask_b32 v18, v10, v7, vcc
    v_cndmask_b32 v22, v10, v9, vcc
    v_cmp_eq_u32 vcc, 3, v6
    s_nop 1
    v_cndmask_b32 v19, v10, v7, vcc
    v_cndmask_b32 v23, v10, v9, vcc
    v_mov_b32 v15, 0
    v_mov_b32 v14, 131072
    v_lshlrev_b32 v8, 4, v0
    v_add_u32 v8, 131200, v8
    s_lshl_b32 s48, s60, 7
    s_add_u32 s48, s48, 131200
    v_lshl_add_u32 v9, v13, 4, s48
    v_lshrrev_b32 v6, 1, v2
    v_lshlrev_b32 v6, 8, v6
    v_and_b32 v7, 7, v1
    v_lshl_add_u32 v6, v7, 5, v6
    v_and_b32 v7, 1, v2
    v_lshl_add_u32 v6, v7, 4, v6
    s_lshl_b32 s48, s60, 9
    s_add_u32 s48, s48, 132096
    v_add_u32 v6, s48, v6
    v_mov_b32 v7, 1
    s_waitcnt vmcnt(9)
    v_lshlrev_b32 v88, 16, v40
    v_and_b32 v89, 0xffff0000, v40
    v_lshlrev_b32 v90, 16, v41
    v_and_b32 v91, 0xffff0000, v41
    v_lshlrev_b32 v92, 16, v42
    v_and_b32 v93, 0xffff0000, v42
    v_lshlrev_b32 v94, 16, v43
    v_and_b32 v95, 0xffff0000, v43
    v_readfirstlane_b32 s48, v88
    v_mov_b32 v104, 0
    v_mov_b32 v106, 0
    s_mov_b32 exec_hi, 0x00ffffff
    v_pk_add_f32 v[96:97], v[88:89], s[48:49] op_sel_hi:[1,0] neg_lo:[0,1] neg_hi:[0,1]
    v_pk_add_f32 v[98:99], v[90:91], s[48:49] op_sel_hi:[1,0] neg_lo:[0,1] neg_hi:[0,1]
    v_pk_add_f32 v[100:101], v[92:93], s[48:49] op_sel_hi:[1,0] neg_lo:[0,1] neg_hi:[0,1]
    v_pk_add_f32 v[102:103], v[94:95], s[48:49] op_sel_hi:[1,0] neg_lo:[0,1] neg_hi:[0,1]
    v_pk_add_f32 v[108:109], v[96:97], v[98:99]
    v_pk_mul_f32 v[106:107], v[96:97], v[96:97]
    v_pk_add_f32 v[104:105], v[100:101], v[102:103]
    v_pk_fma_f32 v[106:107], v[98:99], v[98:99], v[106:107]
    v_pk_add_f32 v[104:105], v[104:105], v[108:109]
    v_pk_fma_f32 v[106:107], v[100:101], v[100:101], v[106:107]
    v_add_f32 v104, v104, v105
    v_pk_fma_f32 v[106:107], v[102:103], v[102:103], v[106:107]
    s_mov_b32 s49, 0x3b124925
    v_add_f32 v106, v106, v107
    s_mov_b32 exec_hi, -1
    s_nop 0
    v_add_f32_dpp v104, v104, v104 row_ror:8 row_mask:0xf bank_mask:0xf
    v_add_f32_dpp v106, v106, v106 row_ror:8 row_mask:0xf bank_mask:0xf
    s_nop 0
    v_add_f32_dpp v104, v104, v104 row_ror:4 row_mask:0xf bank_mask:0xf
    v_add_f32_dpp v106, v106, v106 row_ror:4 row_mask:0xf bank_mask:0xf
    s_nop 0
    v_add_f32_dpp v104, v104, v104 row_ror:2 row_mask:0xf bank_mask:0xf
    v_add_f32_dpp v106, v106, v106 row_ror:2 row_mask:0xf bank_mask:0xf
    s_nop 0
    v_add_f32_dpp v104, v104, v104 row_ror:1 row_mask:0xf bank_mask:0xf
    v_add_f32_dpp v106, v106, v106 row_ror:1 row_mask:0xf bank_mask:0xf
    s_nop 0
    v_add_f32_dpp v104, v104, v104 row_bcast:15 row_mask:0xa bank_mask:0xf
    v_add_f32_dpp v106, v106, v106 row_bcast:15 row_mask:0xa bank_mask:0xf
    s_nop 0
    v_add_f32_dpp v104, v104, v104 row_bcast:31 row_mask:0xc bank_mask:0xf
    v_add_f32_dpp v106, v106, v106 row_bcast:31 row_mask:0xc bank_mask:0xf
    v_mov_b32 v108, s49
    v_readlane_b32 s50, v104, 63
    v_readlane_b32 s51, v106, 63
    s_nop 0
    v_mul_f32 v104, s50, v108
    v_mul_f32 v106, s51, v108
    v_add_f32 v108, s48, v104
    v_fma_f32 v106, -v104, v104, v106
    v_cvt_pk_bf16_f32 v108, v108, v108
    v_max_f32 v106, 0, v106
    v_and_b32 v108, 0xffff0000, v108
    v_cvt_pk_bf16_f32 v106, v106, v106
    v_pk_add_f32 v[96:97], v[88:89], v[108:109] op_sel_hi:[1,0] neg_lo:[0,1] neg_hi:[0,1]
    v_and_b32 v106, 0xffff0000, v106
    v_pk_add_f32 v[98:99], v[90:91], v[108:109] op_sel_hi:[1,0] neg_lo:[0,1] neg_hi:[0,1]
    v_add_f32 v106, 0x3727c5ac, v106
    v_pk_add_f32 v[100:101], v[92:93], v[108:109] op_sel_hi:[1,0] neg_lo:[0,1] neg_hi:[0,1]
    v_cvt_pk_bf16_f32 v106, v106, v106
    v_pk_add_f32 v[102:103], v[94:95], v[108:109] op_sel_hi:[1,0] neg_lo:[0,1] neg_hi:[0,1]
    v_and_b32 v106, 0xffff0000, v106
    v_cvt_pk_bf16_f32 v40, v96, v97
    v_sqrt_f32 v106, v106
    v_cvt_pk_bf16_f32 v41, v98, v99
    v_cvt_pk_bf16_f32 v106, v106, v106
    v_cvt_pk_bf16_f32 v42, v100, v101
    v_and_b32 v106, 0xffff0000, v106
    v_cvt_pk_bf16_f32 v43, v102, v103
    v_rcp_f32 v106, v106
    v_lshlrev_b32 v96, 16, v40
    v_and_b32 v97, 0xffff0000, v40
    v_lshlrev_b32 v98, 16, v41
    v_and_b32 v99, 0xffff0000, v41
    v_lshlrev_b32 v100, 16, v42
    v_and_b32 v101, 0xffff0000, v42
    v_lshlrev_b32 v102, 16, v43
    v_and_b32 v103, 0xffff0000, v43
    v_pk_mul_f32 v[96:97], v[96:97], v[106:107] op_sel_hi:[1,0]
    v_pk_mul_f32 v[98:99], v[98:99], v[106:107] op_sel_hi:[1,0]
    v_pk_mul_f32 v[100:101], v[100:101], v[106:107] op_sel_hi:[1,0]
    v_pk_mul_f32 v[102:103], v[102:103], v[106:107] op_sel_hi:[1,0]
    v_cvt_pk_bf16_f32 v40, v96, v97
    v_cvt_pk_bf16_f32 v41, v98, v99
    v_cvt_pk_bf16_f32 v42, v100, v101
    v_cvt_pk_bf16_f32 v43, v102, v103
    s_mov_b32 exec_hi, 0x00ffffff
    ds_write_b128 v8, v[40:43]
    s_mov_b32 exec_hi, -1
    s_waitcnt lgkmcnt(0)
    ds_read_b128 v[40:43], v9
    s_waitcnt lgkmcnt(0)
    v_perm_b32 v88, v40, v40, v16
    v_perm_b32 v89, v40, v40, v17
    v_perm_b32 v90, v40, v40, v18
    v_perm_b32 v91, v40, v40, v19
    v_perm_b32 v92, v40, v40, v20
    v_perm_b32 v93, v40, v40, v21
    v_perm_b32 v94, v40, v40, v22
    v_perm_b32 v95, v40, v40, v23
    v_perm_b32 v96, v41, v41, v16
    v_perm_b32 v97, v41, v41, v17
    v_perm_b32 v98, v41, v41, v18
    v_perm_b32 v99, v41, v41, v19
    v_perm_b32 v100, v41, v41, v20
    v_perm_b32 v101, v41, v41, v21
    v_perm_b32 v102, v41, v41, v22
    v_perm_b32 v103, v41, v41, v23
    v_perm_b32 v104, v42, v42, v16
    v_perm_b32 v105, v42, v42, v17
    v_perm_b32 v106, v42, v42, v18
    v_perm_b32 v107, v42, v42, v19
    v_perm_b32 v108, v42, v42, v20
    v_perm_b32 v109, v42, v42, v21
    v_perm_b32 v110, v42, v42, v22
    v_perm_b32 v111, v42, v42, v23
    v_perm_b32 v112, v43, v43, v16
    v_perm_b32 v113, v43, v43, v17
    v_perm_b32 v114, v43, v43, v18
    v_perm_b32 v115, v43, v43, v19
    v_perm_b32 v116, v43, v43, v20
    v_perm_b32 v117, v43, v43, v21
    v_perm_b32 v118, v43, v43, v22
    v_perm_b32 v119, v43, v43, v23
    s_waitcnt vmcnt(8)
    v_mfma_f32_16x16x32_bf16 v[32:35], v[88:91], v[56:59], 0
    s_waitcnt vmcnt(7)
    v_mfma_f32_16x16x32_bf16 v[32:35], v[92:95], v[60:63], v[32:35]
    s_waitcnt vmcnt(6)
    v_mfma_f32_16x16x32_bf16 v[32:35], v[96:99], v[64:67], v[32:35]
    s_waitcnt vmcnt(5)
    v_mfma_f32_16x16x32_bf16 v[32:35], v[100:103], v[68:71], v[32:35]
    s_waitcnt vmcnt(4)
    v_mfma_f32_16x16x32_bf16 v[32:35], v[104:107], v[72:75], v[32:35]
    s_waitcnt vmcnt(3)
    v_mfma_f32_16x16x32_bf16 v[32:35], v[108:111], v[76:79], v[32:35]
    s_waitcnt vmcnt(2)
    v_mfma_f32_16x16x32_bf16 v[32:35], v[112:115], v[80:83], v[32:35]
    s_waitcnt vmcnt(1)
    v_mfma_f32_16x16x32_bf16 v[32:35], v[116:119], v[84:87], v[32:35]
    s_mov_b32 exec_lo, 0x00ff00ff
    s_mov_b32 exec_hi, 0xff00ff00
    s_nop 5
    ds_write_b128 v6, v[32:35]
    s_waitcnt lgkmcnt(0)
    s_mov_b64 exec, 1
    ds_add_u32 v14, v7 offset:12
    s_waitcnt vmcnt(0)
    ds_add_u32 v14, v7 offset:36
    s_add_u32 s91, s62, 1
    s_mov_b64 exec, -1
    s_cmp_eq_u32 s3, 3
    s_cbranch_scc1 L_h4
    s_cmp_gt_u32 s3, 3
    s_cbranch_scc1 L_helper
    v_and_b32 v6, 1, v2
    v_lshrrev_b32 v8, 3, v1
    v_cmp_eq_u32 vcc, v6, v8
    s_nop 1
    v_cndmask_b32 v16, v10, v16, vcc
    v_cndmask_b32 v17, v10, v17, vcc
    v_cndmask_b32 v18, v10, v18, vcc
    v_cndmask_b32 v19, v10, v19, vcc
    v_cndmask_b32 v20, v10, v20, vcc
    v_cndmask_b32 v21, v10, v21, vcc
    v_cndmask_b32 v22, v10, v22, vcc
    v_cndmask_b32 v23, v10, v23, vcc
    v_and_b32 v6, 3, v1
    v_xor_b32 v6, v6, v2
    v_and_b32 v7, 12, v1
    v_or_b32 v6, v6, v7
    v_xor_b32 v7, 0, v6
    v_lshlrev_b32 v7, 4, v7
    v_lshl_add_u32 v8, v1, 9, v7
    v_xor_b32 v7, 4, v6
    v_lshlrev_b32 v7, 4, v7
    v_lshl_add_u32 v9, v1, 9, v7
    v_xor_b32 v7, 8, v6
    v_lshlrev_b32 v7, 4, v7
    v_lshl_add_u32 v10, v1, 9, v7
    v_xor_b32 v7, 12, v6
    v_lshlrev_b32 v7, 4, v7
    v_lshl_add_u32 v11, v1, 9, v7
    v_and_b32 v6, 1, v1
    v_lshlrev_b32 v6, 4, v6
    v_and_b32 v7, 14, v1
    v_add_u32 v12, v6, v7
    s_lshl_b32 s48, s60, 5
    s_add_u32 s61, s48, 136192
    v_add_u32 v12, s61, v12
    s_lshl_b32 s48, s60, 2
    s_add_u32 s48, s48, 131076
    v_mov_b32 v13, s48
    s_lshl_b32 s56, s60, 13
    s_add_u32 s57, s60, 1
    s_mov_b32 s58, 0
    v_mov_b32 v5, 0
    v_lshlrev_b32 v7, 4, v2
    v_add_u32 v7, 135680, v7
    s_mov_b32 s63, 1048576
L_poll3:
    ds_read_b32 v6, v14 offset:24
    s_waitcnt lgkmcnt(0)
    v_readfirstlane_b32 s48, v6
    s_cmp_ge_u32 s48, 1
    s_cbranch_scc1 L_go4
    s_sleep 1
    s_sub_u32 s63, s63, 1
    s_cbranch_scc0 L_poll3
L_go4:
    ds_read_b128 v[56:59], v7 offset:0
    ds_read_b128 v[60:63], v7 offset:64
    ds_read_b128 v[64:67], v7 offset:128
    ds_read_b128 v[68:71], v7 offset:192
    ds_read_b128 v[72:75], v7 offset:256
    ds_read_b128 v[76:79], v7 offset:320
    ds_read_b128 v[80:83], v7 offset:384
    ds_read_b128 v[84:87], v7 offset:448
L_kloop:
    v_add_u32 v24, s56, v8
    v_add_u32 v25, s56, v9
    v_add_u32 v26, s56, v10
    v_add_u32 v27, s56, v11
    v_add_u32 v5, 1, v5
    s_cmp_ge_u32 s58, s57
    s_cbranch_scc1 L_go6
    s_mov_b32 s63, 1048576
L_poll5:
    ds_read_b32 v6, v14 offset:0
    s_waitcnt lgkmcnt(0)
    v_readfirstlane_b32 s58, v6
    s_cmp_ge_u32 s58, s57
    s_cbranch_scc1 L_go6
    s_sleep 1
    s_sub_u32 s63, s63, 1
    s_cbranch_scc0 L_poll5
L_go6:
    ds_read_b128 v[88:91], v24 offset:0
    ds_read_b128 v[92:95], v25 offset:0
    ds_read_b128 v[96:99], v26 offset:0
    ds_read_b128 v[100:103], v27 offset:0
    ds_read_b128 v[104:107], v24 offset:256
    ds_read_b128 v[108:111], v25 offset:256
    ds_read_b128 v[112:115], v26 offset:256
    ds_read_b128 v[116:119], v27 offset:256
    s_waitcnt lgkmcnt(7)
    v_mfma_f32_16x16x32_bf16 v[32:35], v[56:59], v[88:91], 0
    s_waitcnt lgkmcnt(6)
    v_mfma_f32_16x16x32_bf16 v[32:35], v[60:63], v[92:95], v[32:35]
    s_waitcnt lgkmcnt(5)
    v_mfma_f32_16x16x32_bf16 v[32:35], v[64:67], v[96:99], v[32:35]
    s_waitcnt lgkmcnt(4)
    v_mfma_f32_16x16x32_bf16 v[32:35], v[68:71], v[100:103], v[32:35]
    s_waitcnt lgkmcnt(3)
    v_mfma_f32_16x16x32_bf16 v[32:35], v[72:75], v[104:107], v[32:35]
    s_waitcnt lgkmcnt(2)
    v_mfma_f32_16x16x32_bf16 v[32:35], v[76:79], v[108:111], v[32:35]
    s_waitcnt lgkmcnt(1)
    v_mfma_f32_16x16x32_bf16 v[32:35], v[80:83], v[112:115], v[32:35]
    s_waitcnt lgkmcnt(0)
    v_mfma_f32_16x16x32_bf16 v[32:35], v[84:87], v[116:119], v[32:35]
    ds_write_b32 v13, v5
    s_add_u32 s56, s56, 16384
    s_and_b32 s56, s56, 0x1ffff
    s_add_u32 s57, s57, 2
    s_nop 4
    v_cvt_pk_bf16_f32 v6, v32, v32
    ds_write_b16 v12, v6
    v_add_u32 v12, 64, v12
    s_cmp_lt_u32 s57, 129
    s_cbranch_scc1 L_kloop
    v_lshl_add_u32 v12, v0, 6, s61
    s_waitcnt lgkmcnt(0)
    ds_read_b128 v[40:43], v12
    ds_read_b128 v[44:47], v12 offset:16
    s_waitcnt lgkmcnt(0)
    v_lshlrev_b32 v88, 16, v40
    v_and_b32 v89, 0xffff0000, v40
    v_lshlrev_b32 v90, 16, v41
    v_and_b32 v91, 0xffff0000, v41
    v_lshlrev_b32 v92, 16, v42
    v_and_b32 v93, 0xffff0000, v42
    v_lshlrev_b32 v94, 16, v43
    v_and_b32 v95, 0xffff0000, v43
    v_lshlrev_b32 v96, 16, v44
    v_and_b32 v97, 0xffff0000, v44
    v_lshlrev_b32 v98, 16, v45
    v_and_b32 v99, 0xffff0000, v45
    v_lshlrev_b32 v100, 16, v46
    v_and_b32 v101, 0xffff0000, v46
    v_lshlrev_b32 v102, 16, v47
    v_and_b32 v103, 0xffff0000, v47
    v_max3_f32 v6, v88, v89, v90
    v_max3_f32 v6, v6, v91, v92
    v_max3_f32 v6, v6, v93, v94
    v_max3_f32 v6, v6, v95, v96
    v_max3_f32 v6, v6, v97, v98
    v_max3_f32 v6, v6, v99, v100
    v_max3_f32 v6, v6, v101, v102
    v_max_f32 v6, v6, v103
    s_nop 1
    v_max_f32_dpp v6, v6, v6 row_ror:8 row_mask:0xf bank_mask:0xf
    s_nop 1
    v_max_f32_dpp v6, v6, v6 row_ror:4 row_mask:0xf bank_mask:0xf
    s_nop 1
    v_max_f32_dpp v6, v6, v6 row_ror:2 row_mask:0xf bank_mask:0xf
    s_nop 1
    v_max_f32_dpp v6, v6, v6 row_ror:1 row_mask:0xf bank_mask:0xf
    s_nop 1
    v_max_f32_dpp v6, v6, v6 row_bcast:15 row_mask:0xa bank_mask:0xf
    s_nop 1
    v_max_f32_dpp v6, v6, v6 row_bcast:31 row_mask:0xc bank_mask:0xf
    s_nop 0
    v_readlane_b32 s48, v6, 63
    s_nop 1
    s_mov_b32 s49, 0x3db8aa3b
    v_subrev_f32 v88, s48, v88
    v_subrev_f32 v89, s48, v89
    v_subrev_f32 v90, s48, v90
    v_subrev_f32 v91, s48, v91
    v_subrev_f32 v92, s48, v92
    v_subrev_f32 v93, s48, v93
    v_subrev_f32 v94, s48, v94
    v_subrev_f32 v95, s48, v95
    v_subrev_f32 v96, s48, v96
    v_subrev_f32 v97, s48, v97
    v_subrev_f32 v98, s48, v98
    v_subrev_f32 v99, s48, v99
    v_subrev_f32 v100, s48, v100
    v_subrev_f32 v101, s48, v101
    v_subrev_f32 v102, s48, v102
    v_subrev_f32 v103, s48, v103
    v_mul_f32 v88, s49, v88
    v_mul_f32 v89, s49, v89
    v_mul_f32 v90, s49, v90
    v_mul_f32 v91, s49, v91
    v_mul_f32 v92, s49, v92
    v_mul_f32 v93, s49, v93
    v_mul_f32 v94, s49, v94
    v_mul_f32 v95, s49, v95
    v_mul_f32 v96, s49, v96
    v_mul_f32 v97, s49, v97
    v_mul_f32 v98, s49, v98
    v_mul_f32 v99, s49, v99
    v_mul_f32 v100, s49, v100
    v_mul_f32 v101, s49, v101
    v_mul_f32 v102, s49, v102
    v_mul_f32 v103, s49, v103
    v_exp_f32 v88, v88
    v_exp_f32 v89, v89
    v_exp_f32 v90, v90
    v_exp_f32 v91, v91
    v_exp_f32 v92, v92
    v_exp_f32 v93, v93
    v_exp_f32 v94, v94
    v_exp_f32 v95, v95
    v_exp_f32 v96, v96
    v_exp_f32 v97, v97
    v_exp_f32 v98, v98
    v_exp_f32 v99, v99
    v_exp_f32 v100, v100
    v_exp_f32 v101, v101
    v_exp_f32 v102, v102
    v_exp_f32 v103, v103
    s_nop 0
    v_cvt_pk_bf16_f32 v40, v88, v89
    v_cvt_pk_bf16_f32 v41, v90, v91
    v_cvt_pk_bf16_f32 v42, v92, v93
    v_cvt_pk_bf16_f32 v43, v94, v95
    v_cvt_pk_bf16_f32 v44, v96, v97
    v_cvt_pk_bf16_f32 v45, v98, v99
    v_cvt_pk_bf16_f32 v46, v100, v101
    v_cvt_pk_bf16_f32 v47, v102, v103
    ds_write_b128 v12, v[40:43]
    ds_write_b128 v12, v[44:47] offset:16
    v_add_f32 v88, v88, v96
    v_add_f32 v89, v89, v97
    v_add_f32 v90, v90, v98
    v_add_f32 v91, v91, v99
    v_add_f32 v92, v92, v100
    v_add_f32 v93, v93, v101
    v_add_f32 v94, v94, v102
    v_add_f32 v95, v95, v103
    v_add_f32 v88, v88, v92
    v_add_f32 v89, v89, v93
    v_add_f32 v90, v90, v94
    v_add_f32 v91, v91, v95
    v_add_f32 v88, v88, v90
    v_add_f32 v89, v89, v91
    v_add_f32 v88, v88, v89
    s_nop 1
    v_add_f32_dpp v88, v88, v88 row_ror:8 row_mask:0xf bank_mask:0xf
    s_nop 1
    v_add_f32_dpp v88, v88, v88 row_ror:4 row_mask:0xf bank_mask:0xf
    s_nop 1
    v_add_f32_dpp v88, v88, v88 row_ror:2 row_mask:0xf bank_mask:0xf
    s_nop 1
    v_add_f32_dpp v88, v88, v88 row_ror:1 row_mask:0xf bank_mask:0xf
    s_nop 1
    v_add_f32_dpp v88, v88, v88 row_bcast:15 row_mask:0xa bank_mask:0xf
    s_nop 1
    v_add_f32_dpp v88, v88, v88 row_bcast:31 row_mask:0xc bank_mask:0xf
    s_nop 0
    v_readlane_b32 s49, v88, 63
    s_nop 1
    v_mov_b32 v6, s48
    v_mov_b32 v7, s49
    s_lshl_b32 s48, s60, 3
    s_add_u32 s48, s48, 131136
    v_mov_b32 v8, s48
    v_mov_b32 v9, 1
    s_mov_b64 exec, 1
    ds_write_b64 v8, v[6:7]
    s_waitcnt lgkmcnt(0)
    ds_add_u32 v14, v9 offset:16
    s_mov_b64 exec, -1
    v_lshlrev_b32 v8, 4, v0
    v_lshl_add_u32 v12, v3, 4, s61
    v_add_u32 v10, 140288, v8
    v_mov_b32 v32, 0
    v_mov_b32 v33, 0
    v_mov_b32 v34, 0
    v_mov_b32 v35, 0
    s_mov_b32 s59, 225
L_vloop:
    ds_read_b128 v[40:43], v12
    v_add_u32 v9, s56, v8
    v_add_u32 v12, 64, v12
    v_add_u32 v5, 1, v5
    s_waitcnt lgkmcnt(0)
    v_perm_b32 v56, v40, v40, v16
    v_perm_b32 v57, v40, v40, v17
    v_perm_b32 v58, v40, v40, v18
    v_perm_b32 v59, v40, v40, v19
    v_perm_b32 v60, v40, v40, v20
    v_perm_b32 v61, v40, v40, v21
    v_perm_b32 v62, v40, v40, v22
    v_perm_b32 v63, v40, v40, v23
    v_perm_b32 v64, v41, v41, v16
    v_perm_b32 v65, v41, v41, v17
    v_perm_b32 v66, v41, v41, v18
    v_perm_b32 v67, v41, v41, v19
    v_perm_b32 v68, v41, v41, v20
    v_perm_b32 v69, v41, v41, v21
    v_perm_b32 v70, v41, v41, v22
    v_perm_b32 v71, v41, v41, v23
    v_perm_b32 v72, v42, v42, v16
    v_perm_b32 v73, v42, v42, v17
    v_perm_b32 v74, v42, v42, v18
    v_perm_b32 v75, v42, v42, v19
    v_perm_b32 v76, v42, v42, v20
    v_perm_b32 v77, v42, v42, v21
    v_perm_b32 v78, v42, v42, v22
    v_perm_b32 v79, v42, v42, v23
    v_perm_b32 v80, v43, v43, v16
    v_perm_b32 v81, v43, v43, v17
    v_perm_b32 v82, v43, v43, v18
    v_perm_b32 v83, v43, v43, v19
    v_perm_b32 v84, v43, v43, v20
    v_perm_b32 v85, v43, v43, v21
    v_perm_b32 v86, v43, v43, v22
    v_perm_b32 v87, v43, v43, v23
    s_cmp_ge_u32 s58, s57
    s_cbranch_scc1 L_go8
    s_mov_b32 s63, 1048576
L_poll7:
    ds_read_b32 v6, v14 offset:0
    s_waitcnt lgkmcnt(0)
    v_readfirstlane_b32 s58, v6
    s_cmp_ge_u32 s58, s57
    s_cbranch_scc1 L_go8
    s_sleep 1
    s_sub_u32 s63, s63, 1
    s_cbranch_scc0 L_poll7
L_go8:
    ds_read_b128 v[88:91], v9 offset:0
    ds_read_b128 v[92:95], v9 offset:1024
    ds_read_b128 v[96:99], v9 offset:2048
    ds_read_b128 v[100:103], v9 offset:3072
    ds_read_b128 v[104:107], v9 offset:4096
    ds_read_b128 v[108:111], v9 offset:5120
    ds_read_b128 v[112:115], v9 offset:6144
    ds_read_b128 v[116:119], v9 offset:7168
    ds_read_b32 v6, v14 offset:32
    ds_read_b128 v[36:39], v10
    s_waitcnt lgkmcnt(9)
    v_mfma_f32_16x16x32_bf16 v[32:35], v[56:59], v[88:91], v[32:35]
    s_waitcnt lgkmcnt(8)
    v_mfma_f32_16x16x32_bf16 v[32:35], v[60:63], v[92:95], v[32:35]
    s_waitcnt lgkmcnt(7)
    v_mfma_f32_16x16x32_bf16 v[32:35], v[64:67], v[96:99], v[32:35]
    s_waitcnt lgkmcnt(6)
    v_mfma_f32_16x16x32_bf16 v[32:35], v[68:71], v[100:103], v[32:35]
    s_waitcnt lgkmcnt(5)
    v_mfma_f32_16x16x32_bf16 v[32:35], v[72:75], v[104:107], v[32:35]
    s_waitcnt lgkmcnt(4)
    v_mfma_f32_16x16x32_bf16 v[32:35], v[76:79], v[108:111], v[32:35]
    s_waitcnt lgkmcnt(3)
    v_mfma_f32_16x16x32_bf16 v[32:35], v[80:83], v[112:115], v[32:35]
    s_waitcnt lgkmcnt(2)
    v_mfma_f32_16x16x32_bf16 v[32:35], v[84:87], v[116:119], v[32:35]
    ds_write_b32 v13, v5
    s_add_u32 s56, s56, 16384
    s_and_b32 s56, s56, 0x1ffff
    s_add_u32 s57, s57, 2
    s_cmp_lt_u32 s57, s59
    s_cbranch_scc1 L_vloop
    s_cmp_gt_u32 s59, 253
    s_cbranch_scc1 L_vdone
    s_cmp_gt_u32 s59, 240
    s_cbranch_scc1 L_vdir
    s_mov_b32 s63, 1048576
L_poll9:
    ds_read_b32 v6, v14 offset:20
    s_waitcnt lgkmcnt(0)
    v_readfirstlane_b32 s48, v6
    s_cmp_ge_u32 s48, 1
    s_cbranch_scc1 L_go10
    s_sleep 1
    s_sub_u32 s63, s63, 1
    s_cbranch_scc0 L_poll9
L_go10:
    s_lshl_b32 s48, s60, 2
    s_add_u32 s48, s48, 131152
    v_mov_b32 v11, s48
    ds_read_b32 v11, v11
    v_lshrrev_b32 v6, 3, v1
    v_lshl_add_u32 v6, v3, 1, v6
    v_lshlrev_b32 v7, 11, v6
    v_and_b32 v6, 7, v1
    v_lshl_add_u32 v7, v6, 4, v7
    v_and_b32 v6, 1, v2
    v_lshl_add_u32 v7, v6, 3, v7
    s_lshl_b32 s48, s28, 13
    s_lshl_b32 s49, s30, 2
    s_add_u32 s49, s49, s29
    s_lshl_b32 s49, s49, 7
    s_add_u32 s48, s48, s49
    s_add_u32 s61, s48, 860160
    s_lshl_b32 s48, s31, 22
    s_lshl_b32 s49, s29, 20
    s_add_u32 s48, s48, s49
    s_add_u32 s36, s8, s48
    s_addc_u32 s37, s9, 0
    s_and_b32 s37, s37, 0xffff
    s_mov_b32 s38, 1048576
    s_mov_b32 s39, 0x20000
    s_mov_b32 s59, 251
    s_branch L_vloop
L_vdir:
    s_cmp_ge_u32 s58, s57
    s_cbranch_scc1 L_go12
    s_mov_b32 s63, 1048576
L_poll11:
    ds_read_b32 v6, v14 offset:0
    s_waitcnt lgkmcnt(0)
    v_readfirstlane_b32 s58, v6
    s_cmp_ge_u32 s58, s57
    s_cbranch_scc1 L_go12
    s_sleep 1
    s_sub_u32 s63, s63, 1
    s_cbranch_scc0 L_poll11
L_go12:
    s_mul_i32 s48, s60, 8192
    s_add_u32 s48, s48, 1032192
    buffer_load_dwordx4 v[120:123], v8, s[36:39], s48 offen offset:0 nt
    buffer_load_dwordx4 v[124:127], v8, s[36:39], s48 offen offset:1024 nt
    buffer_load_dwordx4 v[128:131], v8, s[36:39], s48 offen offset:2048 nt
    buffer_load_dwordx4 v[132:135], v8, s[36:39], s48 offen offset:3072 nt
    s_add_u32 s48, s48, 4096
    buffer_load_dwordx4 v[136:139], v8, s[36:39], s48 offen offset:0 nt
    buffer_load_dwordx4 v[140:143], v8, s[36:39], s48 offen offset:1024 nt
    buffer_load_dwordx4 v[144:147], v8, s[36:39], s48 offen offset:2048 nt
    buffer_load_dwordx4 v[148:151], v8, s[36:39], s48 offen offset:3072 nt
    s_mov_b32 s59, 255
    s_branch L_vloop
L_vdone:
    ds_read_b128 v[40:43], v12
    s_waitcnt lgkmcnt(0)
    v_perm_b32 v56, v40, v40, v16
    v_perm_b32 v57, v40, v40, v17
    v_perm_b32 v58, v40, v40, v18
    v_perm_b32 v59, v40, v40, v19
    v_perm_b32 v60, v40, v40, v20
    v_perm_b32 v61, v40, v40, v21
    v_perm_b32 v62, v40, v40, v22
    v_perm_b32 v63, v40, v40, v23
    v_perm_b32 v64, v41, v41, v16
    v_perm_b32 v65, v41, v41, v17
    v_perm_b32 v66, v41, v41, v18
    v_perm_b32 v67, v41, v41, v19
    v_perm_b32 v68, v41, v41, v20
    v_perm_b32 v69, v41, v41, v21
    v_perm_b32 v70, v41, v41, v22
    v_perm_b32 v71, v41, v41, v23
    v_perm_b32 v72, v42, v42, v16
    v_perm_b32 v73, v42, v42, v17
    v_perm_b32 v74, v42, v42, v18
    v_perm_b32 v75, v42, v42, v19
    v_perm_b32 v76, v42, v42, v20
    v_perm_b32 v77, v42, v42, v21
    v_perm_b32 v78, v42, v42, v22
    v_perm_b32 v79, v42, v42, v23
    v_perm_b32 v80, v43, v43, v16
    v_perm_b32 v81, v43, v43, v17
    v_perm_b32 v82, v43, v43, v18
    v_perm_b32 v83, v43, v43, v19
    v_perm_b32 v84, v43, v43, v20
    v_perm_b32 v85, v43, v43, v21
    v_perm_b32 v86, v43, v43, v22
    v_perm_b32 v87, v43, v43, v23
    s_waitcnt vmcnt(7)
    v_mfma_f32_16x16x32_bf16 v[32:35], v[56:59], v[120:123], v[32:35]
    s_waitcnt vmcnt(6)
    v_mfma_f32_16x16x32_bf16 v[32:35], v[60:63], v[124:127], v[32:35]
    s_waitcnt vmcnt(5)
    v_mfma_f32_16x16x32_bf16 v[32:35], v[64:67], v[128:131], v[32:35]
    s_waitcnt vmcnt(4)
    v_mfma_f32_16x16x32_bf16 v[32:35], v[68:71], v[132:135], v[32:35]
    s_waitcnt vmcnt(3)
    v_mfma_f32_16x16x32_bf16 v[32:35], v[72:75], v[136:139], v[32:35]
    s_waitcnt vmcnt(2)
    ds_read_b32 v6, v14 offset:32
    ds_read_b128 v[36:39], v10
    v_mfma_f32_16x16x32_bf16 v[32:35], v[76:79], v[140:143], v[32:35]
    s_waitcnt vmcnt(1)
    v_mfma_f32_16x16x32_bf16 v[32:35], v[80:83], v[144:147], v[32:35]
    s_waitcnt vmcnt(0)
    v_mfma_f32_16x16x32_bf16 v[32:35], v[84:87], v[148:151], v[32:35]
    s_nop 5
    s_cmp_eq_u32 s60, 0
    s_cbranch_scc0 L_vpub
    v_mul_f32 v32, v11, v32
    v_mul_f32 v33, v11, v33
    v_mul_f32 v34, v11, v34
    v_mul_f32 v35, v11, v35
    v_mov_b32 v9, 1
    ds_write_b128 v10, v[32:35]
    s_waitcnt lgkmcnt(0)
    ds_write_b32 v14, v9 offset:32
    s_waitcnt lgkmcnt(0)
    s_endpgm
L_vpub:
    s_waitcnt lgkmcnt(0)
    v_readfirstlane_b32 s48, v6
    s_cmp_eq_u32 s48, 1
    s_cbranch_scc1 L_vsum
    s_mov_b32 s63, 1048576
L_poll13:
    ds_read_b32 v6, v14 offset:32
    s_waitcnt lgkmcnt(0)
    v_readfirstlane_b32 s48, v6
    s_cmp_ge_u32 s48, 1
    s_cbranch_scc1 L_go14
    s_sub_u32 s63, s63, 1
    s_cbranch_scc0 L_poll13
L_go14:
    ds_read_b128 v[36:39], v10
    s_waitcnt lgkmcnt(0)
L_vsum:
    v_fma_f32 v32, v11, v32, v36
    v_fma_f32 v33, v11, v33, v37
    v_fma_f32 v34, v11, v34, v38
    v_fma_f32 v35, v11, v35, v39
    v_cvt_pk_bf16_f32 v32, v32, v33
    v_cvt_pk_bf16_f32 v33, v34, v35
    v_min_u32 v32, -2, v32
    v_min_u32 v33, -2, v33
    buffer_store_dwordx2 v[32:33], v7, s[40:43], s61 offen sc1
    v_mov_b32 v9, 1
    ds_write_b32 v14, v9 offset:40
    s_waitcnt lgkmcnt(0)
    s_endpgm
L_pace:
    s_cmp_ge_u32 s58, s56
    s_cbranch_scc1 L_go16
    s_mov_b32 s63, 1048576
L_poll15:
    ds_read_b32 v12, v14 offset:0
    s_waitcnt lgkmcnt(0)
    v_readfirstlane_b32 s58, v12
    s_cmp_ge_u32 s58, s56
    s_cbranch_scc1 L_go16
    s_sleep 8
    s_sub_u32 s63, s63, 1
    s_cbranch_scc0 L_poll15
L_go16:
    s_add_u32 s56, s56, s57
    s_setpc_b64 s[54:55]
L_helper:
    s_getpc_b64 s[52:53]
L_pc17:
    s_sub_u32 s52, s52, L_pc17-L_pace
    s_subb_u32 s53, s53, 0
    s_mov_b32 s58, 0
    s_sub_u32 s62, s3, 4
    s_and_b32 s48, s2, 7
    s_mul_i32 s48, s48, 7
    s_lshr_b32 s49, s2, 3
    s_add_u32 s59, s48, s49
    s_cmp_ge_u32 s2, 56
    s_cbranch_scc1 L_noffn
    s_cmp_ge_u32 s62, 2
    s_cselect_b32 s44, s18, s16
    s_cselect_b32 s45, s19, s17
    s_and_b32 s45, s45, 0xffff
    s_mov_b32 s46, 1605632
    s_mov_b32 s47, 0x20000
    v_lshrrev_b32 v7, 2, v0
    v_and_b32 v8, 7, v7
    v_lshrrev_b32 v6, 3, v7
    v_lshl_add_u32 v6, v8, 2, v6
    v_mul_u32_u24 v6, 3584, v6
    v_and_b32 v8, 3, v0
    v_lshl_add_u32 v6, v8, 4, v6
    s_and_b32 s48, s62, 1
    s_mul_i32 s50, s48, 802816
    s_lshl_b32 s49, s59, 6
    s_add_u32 s50, s50, s49
    s_lshl_b32 s51, s62, 11
    s_add_u32 s51, s51, 151040
    v_lshrrev_b32 v9, 2, v1
    v_lshl_add_u32 v10, v2, 3, v9
    v_lshlrev_b32 v10, 6, v10
    v_and_b32 v11, 3, v1
    v_lshl_add_u32 v10, v11, 3, v10
    v_add_u32 v10, s51, v10
    s_mov_b32 s56, 24
    s_mov_b32 s57, 1
    s_swappc_b64 s[54:55], s[52:53]
    s_mov_b32 m0, s51
    s_nop 0
    buffer_load_dwordx4 v6, s[44:47], s50 offen nt lds
    s_swappc_b64 s[54:55], s[52:53]
    s_add_u32 m0, s51, 1024
    s_add_u32 s50, s50, 7168
    buffer_load_dwordx4 v6, s[44:47], s50 offen nt lds
    s_add_u32 s50, s50, 107520
    s_waitcnt vmcnt(0)
    ds_read_b64_tr_b16 v[184:185], v10 offset:0
    ds_read_b64_tr_b16 v[186:187], v10 offset:256
    ds_read_b64_tr_b16 v[188:189], v10 offset:32
    ds_read_b64_tr_b16 v[190:191], v10 offset:288
    s_waitcnt lgkmcnt(0)
    s_swappc_b64 s[54:55], s[52:53]
    s_mov_b32 m0, s51
    s_nop 0
    buffer_load_dwordx4 v6, s[44:47], s50 offen nt lds
    s_swappc_b64 s[54:55], s[52:53]
    s_add_u32 m0, s51, 1024
    s_add_u32 s50, s50, 7168
    buffer_load_dwordx4 v6, s[44:47], s50 offen nt lds
    s_add_u32 s50, s50, 107520
    s_waitcnt vmcnt(0)
    ds_read_b64_tr_b16 v[192:193], v10 offset:0
    ds_read_b64_tr_b16 v[194:195], v10 offset:256
    ds_read_b64_tr_b16 v[196:197], v10 offset:32
    ds_read_b64_tr_b16 v[198:199], v10 offset:288
    s_waitcnt lgkmcnt(0)
    s_swappc_b64 s[54:55], s[52:53]
    s_mov_b32 m0, s51
    s_nop 0
    buffer_load_dwordx4 v6, s[44:47], s50 offen nt lds
    s_swappc_b64 s[54:55], s[52:53]
    s_add_u32 m0, s51, 1024
    s_add_u32 s50, s50, 7168
    buffer_load_dwordx4 v6, s[44:47], s50 offen nt lds
    s_add_u32 s50, s50, 107520
    s_waitcnt vmcnt(0)
    ds_read_b64_tr_b16 v[200:201], v10 offset:0
    ds_read_b64_tr_b16 v[202:203], v10 offset:256
    ds_read_b64_tr_b16 v[204:205], v10 offset:32
    ds_read_b64_tr_b16 v[206:207], v10 offset:288
    s_waitcnt lgkmcnt(0)
    s_mov_b32 s44, s20
    s_and_b32 s45, s21, 0xffff
    s_mov_b32 s46, 1605632
    s_mov_b32 s47, 0x20000
    v_mul_u32_u24 v6, 896, v7
    v_lshl_add_u32 v6, v8, 4, v6
    s_mul_i32 s50, s59, 28672
    s_lshl_b32 s49, s62, 8
    s_add_u32 s50, s50, s49
    v_lshl_add_u32 v10, v2, 2, v9
    v_lshlrev_b32 v10, 6, v10
    v_lshl_add_u32 v10, v11, 3, v10
    v_add_u32 v10, s51, v10
    s_branch L_ffn
L_noffn:
    s_sub_u32 s59, s2, 56
    s_cmp_lt_u32 s59, 64
    s_cbranch_scc0 L_r1
    s_mov_b32 s36, s12
    s_and_b32 s37, s13, 0xffff
    s_mov_b32 s38, 3670016
    s_mov_b32 s39, 0x20000
    v_mul_u32_u24 v4, 7168, v2
    v_lshl_add_u32 v4, v1, 3, v4
    s_lshl_b32 s47, s62, 8
    s_cmp_eq_u32 s62, 3
    s_cselect_b32 s47, 704, s47
    s_mul_i32 s48, s59, 57344
    s_add_u32 s48, s48, s47
    v_add_u32 v4, s48, v4
    s_mov_b32 s56, 32
    s_mov_b32 s57, 1
    s_swappc_b64 s[54:55], s[52:53]
    s_mov_b32 s48, 0
    buffer_load_dwordx2 v[120:121], v4, s[36:39], s48 offen offset:0 nt
    buffer_load_dwordx2 v[122:123], v4, s[36:39], s48 offen offset:128 nt
    s_swappc_b64 s[54:55], s[52:53]
    buffer_load_dwordx2 v[124:125], v4, s[36:39], s48 offen offset:896 nt
    buffer_load_dwordx2 v[126:127], v4, s[36:39], s48 offen offset:1024 nt
    s_swappc_b64 s[54:55], s[52:53]
    buffer_load_dwordx2 v[128:129], v4, s[36:39], s48 offen offset:1792 nt
    buffer_load_dwordx2 v[130:131], v4, s[36:39], s48 offen offset:1920 nt
    s_swappc_b64 s[54:55], s[52:53]
    buffer_load_dwordx2 v[132:133], v4, s[36:39], s48 offen offset:2688 nt
    buffer_load_dwordx2 v[134:135], v4, s[36:39], s48 offen offset:2816 nt
    s_swappc_b64 s[54:55], s[52:53]
    s_mov_b32 s48, 3584
    buffer_load_dwordx2 v[136:137], v4, s[36:39], s48 offen offset:0 nt
    buffer_load_dwordx2 v[138:139], v4, s[36:39], s48 offen offset:128 nt
    s_swappc_b64 s[54:55], s[52:53]
    buffer_load_dwordx2 v[140:141], v4, s[36:39], s48 offen offset:896 nt
    buffer_load_dwordx2 v[142:143], v4, s[36:39], s48 offen offset:1024 nt
    s_swappc_b64 s[54:55], s[52:53]
    buffer_load_dwordx2 v[144:145], v4, s[36:39], s48 offen offset:1792 nt
    buffer_load_dwordx2 v[146:147], v4, s[36:39], s48 offen offset:1920 nt
    s_swappc_b64 s[54:55], s[52:53]
    buffer_load_dwordx2 v[148:149], v4, s[36:39], s48 offen offset:2688 nt
    buffer_load_dwordx2 v[150:151], v4, s[36:39], s48 offen offset:2816 nt
    s_swappc_b64 s[54:55], s[52:53]
    s_mov_b32 s48, 28672
    buffer_load_dwordx2 v[152:153], v4, s[36:39], s48 offen offset:0 nt
    buffer_load_dwordx2 v[154:155], v4, s[36:39], s48 offen offset:128 nt
    s_swappc_b64 s[54:55], s[52:53]
    buffer_load_dwordx2 v[156:157], v4, s[36:39], s48 offen offset:896 nt
    buffer_load_dwordx2 v[158:159], v4, s[36:39], s48 offen offset:1024 nt
    s_swappc_b64 s[54:55], s[52:53]
    buffer_load_dwordx2 v[160:161], v4, s[36:39], s48 offen offset:1792 nt
    buffer_load_dwordx2 v[162:163], v4, s[36:39], s48 offen offset:1920 nt
    s_swappc_b64 s[54:55], s[52:53]
    buffer_load_dwordx2 v[164:165], v4, s[36:39], s48 offen offset:2688 nt
    buffer_load_dwordx2 v[166:167], v4, s[36:39], s48 offen offset:2816 nt
    s_swappc_b64 s[54:55], s[52:53]
    s_mov_b32 s48, 32256
    buffer_load_dwordx2 v[168:169], v4, s[36:39], s48 offen offset:0 nt
    buffer_load_dwordx2 v[170:171], v4, s[36:39], s48 offen offset:128 nt
    s_swappc_b64 s[54:55], s[52:53]
    buffer_load_dwordx2 v[172:173], v4, s[36:39], s48 offen offset:896 nt
    buffer_load_dwordx2 v[174:175], v4, s[36:39], s48 offen offset:1024 nt
    s_swappc_b64 s[54:55], s[52:53]
    buffer_load_dwordx2 v[176:177], v4, s[36:39], s48 offen offset:1792 nt
    buffer_load_dwordx2 v[178:179], v4, s[36:39], s48 offen offset:1920 nt
    s_swappc_b64 s[54:55], s[52:53]
    buffer_load_dwordx2 v[180:181], v4, s[36:39], s48 offen offset:2688 nt
    buffer_load_dwordx2 v[182:183], v4, s[36:39], s48 offen offset:2816 nt
    v_lshlrev_b32 v5, 7, v1
    v_lshl_add_u32 v5, v2, 4, v5
    s_lshl_b32 s44, s59, 11
    s_add_u32 s44, s44, 860160
    s_add_u32 s45, s44, 64
    v_mul_u32_u24 v7, 114688, v2
    v_lshl_add_u32 v7, v1, 4, v7
    s_mul_i32 s46, s59, 1792
    s_lshl_b32 s48, s47, 1
    s_add_u32 s46, s46, s48
    s_cmp_ge_u32 s62, 2
    s_cselect_b32 s38, 0x00ff00ff, -1
    s_mov_b32 s39, s38
    s_mov_b32 s48, 0x05040100
    s_mov_b32 s49, 0x07060302
    s_waitcnt vmcnt(0)
    v_perm_b32 v88, v124, v120, s48
    v_perm_b32 v89, v132, v128, s48
    v_perm_b32 v90, v140, v136, s48
    v_perm_b32 v91, v148, v144, s48
    v_perm_b32 v92, v124, v120, s49
    v_perm_b32 v93, v132, v128, s49
    v_perm_b32 v94, v140, v136, s49
    v_perm_b32 v95, v148, v144, s49
    v_perm_b32 v96, v125, v121, s48
    v_perm_b32 v97, v133, v129, s48
    v_perm_b32 v98, v141, v137, s48
    v_perm_b32 v99, v149, v145, s48
    v_perm_b32 v100, v125, v121, s49
    v_perm_b32 v101, v133, v129, s49
    v_perm_b32 v102, v141, v137, s49
    v_perm_b32 v103, v149, v145, s49
    v_perm_b32 v104, v126, v122, s48
    v_perm_b32 v105, v134, v130, s48
    v_perm_b32 v106, v142, v138, s48
    v_perm_b32 v107, v150, v146, s48
    v_perm_b32 v108, v126, v122, s49
    v_perm_b32 v109, v134, v130, s49
    v_perm_b32 v110, v142, v138, s49
    v_perm_b32 v111, v150, v146, s49
    v_perm_b32 v112, v127, v123, s48
    v_perm_b32 v113, v135, v131, s48
    v_perm_b32 v114, v143, v139, s48
    v_perm_b32 v115, v151, v147, s48
    v_perm_b32 v116, v127, v123, s49
    v_perm_b32 v117, v135, v131, s49
    v_perm_b32 v118, v143, v139, s49
    v_perm_b32 v119, v151, v147, s49
    v_perm_b32 v120, v156, v152, s48
    v_perm_b32 v121, v164, v160, s48
    v_perm_b32 v122, v172, v168, s48
    v_perm_b32 v123, v180, v176, s48
    v_perm_b32 v124, v156, v152, s49
    v_perm_b32 v125, v164, v160, s49
    v_perm_b32 v126, v172, v168, s49
    v_perm_b32 v127, v180, v176, s49
    v_perm_b32 v128, v157, v153, s48
    v_perm_b32 v129, v165, v161, s48
    v_perm_b32 v130, v173, v169, s48
    v_perm_b32 v131, v181, v177, s48
    v_perm_b32 v132, v157, v153, s49
    v_perm_b32 v133, v165, v161, s49
    v_perm_b32 v134, v173, v169, s49
    v_perm_b32 v135, v181, v177, s49
    v_perm_b32 v136, v158, v154, s48
    v_perm_b32 v137, v166, v162, s48
    v_perm_b32 v138, v174, v170, s48
    v_perm_b32 v139, v182, v178, s48
    v_perm_b32 v140, v158, v154, s49
    v_perm_b32 v141, v166, v162, s49
    v_perm_b32 v142, v174, v170, s49
    v_perm_b32 v143, v182, v178, s49
    v_perm_b32 v144, v159, v155, s48
    v_perm_b32 v145, v167, v163, s48
    v_perm_b32 v146, v175, v171, s48
    v_perm_b32 v147, v183, v179, s48
    v_perm_b32 v148, v159, v155, s49
    v_perm_b32 v149, v167, v163, s49
    v_perm_b32 v150, v175, v171, s49
    v_perm_b32 v151, v183, v179, s49
    s_mov_b32 s63, 1048576
L_poll18:
    ds_read_b32 v6, v14 offset:20
    s_waitcnt lgkmcnt(0)
    v_readfirstlane_b32 s48, v6
    s_cmp_ge_u32 s48, 1
    s_cbranch_scc1 L_go19
    s_sleep 16
    s_sub_u32 s63, s63, 1
    s_cbranch_scc0 L_poll18
L_go19:
    s_mov_b32 s63, 1048576
L_poll20:
    ds_read_b32 v6, v14 offset:32
    s_waitcnt lgkmcnt(0)
    v_readfirstlane_b32 s48, v6
    s_cmp_ge_u32 s48, 1
    s_cbranch_scc1 L_go21
    s_sleep 4
    s_sub_u32 s63, s63, 1
    s_cbranch_scc0 L_poll20
L_go21:
    s_mov_b64 exec, -1
    buffer_load_dwordx4 v[40:43], v5, s[40:43], s44 offen sc1
    buffer_load_dwordx4 v[44:47], v5, s[40:43], s45 offen sc1
    s_mov_b64 exec, -1
    s_waitcnt vmcnt(1)
    v_max3_u32 v6, v40, v41, v42
    v_max_u32 v6, v6, v43
    v_cmp_eq_u32 s[80:81], -1, v6
    s_waitcnt vmcnt(0)
    v_max3_u32 v6, v44, v45, v46
    v_max_u32 v6, v6, v47
    v_cmp_eq_u32 s[82:83], -1, v6
    s_or_b64 s[50:51], s[80:81], s[82:83]
    s_cbranch_scc0 L_gg23
    s_or_b64 exec, s[80:81], 1
    buffer_load_dwordx4 v[40:43], v5, s[40:43], s44 offen sc1
    s_or_b64 exec, s[82:83], 1
    buffer_load_dwordx4 v[44:47], v5, s[40:43], s45 offen sc1
    s_sleep 5
    s_or_b64 exec, s[80:81], 1
    buffer_load_dwordx4 v[40:43], v5, s[40:43], s44 offen sc1
    s_or_b64 exec, s[82:83], 1
    buffer_load_dwordx4 v[44:47], v5, s[40:43], s45 offen sc1
    s_mov_b32 s63, 131072
L_gp22:
    s_mov_b64 exec, -1
    s_waitcnt vmcnt(3)
    v_max3_u32 v6, v40, v41, v42
    v_max_u32 v6, v6, v43
    v_cmp_eq_u32 s[80:81], -1, v6
    s_waitcnt vmcnt(2)
    v_max3_u32 v6, v44, v45, v46
    v_max_u32 v6, v6, v47
    v_cmp_eq_u32 s[82:83], -1, v6
    s_or_b64 s[50:51], s[80:81], s[82:83]
    s_cbranch_scc0 L_gg23
    s_or_b64 exec, s[80:81], 1
    buffer_load_dwordx4 v[40:43], v5, s[40:43], s44 offen sc1
    s_or_b64 exec, s[82:83], 1
    buffer_load_dwordx4 v[44:47], v5, s[40:43], s45 offen sc1
    s_sub_u32 s63, s63, 1
    s_cbranch_scc0 L_gp22
L_gg23:
    s_mov_b64 exec, -1
L_r0body:
    v_mfma_f32_16x16x32_bf16 v[152:155], v[40:43], v[88:91], 0
    v_mfma_f32_16x16x32_bf16 v[152:155], v[44:47], v[120:123], v[152:155]
    v_mfma_f32_16x16x32_bf16 v[156:159], v[40:43], v[92:95], 0
    v_mfma_f32_16x16x32_bf16 v[156:159], v[44:47], v[124:127], v[156:159]
    v_mfma_f32_16x16x32_bf16 v[160:163], v[40:43], v[96:99], 0
    v_mfma_f32_16x16x32_bf16 v[160:163], v[44:47], v[128:131], v[160:163]
    v_mfma_f32_16x16x32_bf16 v[164:167], v[40:43], v[100:103], 0
    v_mfma_f32_16x16x32_bf16 v[164:167], v[44:47], v[132:135], v[164:167]
    v_mfma_f32_16x16x32_bf16 v[168:171], v[40:43], v[104:107], 0
    v_mfma_f32_16x16x32_bf16 v[168:171], v[44:47], v[136:139], v[168:171]
    v_pk_add_f32 v[152:153], v[152:153], v[154:155]
    v_add_f32 v24, v152, v153
    v_mfma_f32_16x16x32_bf16 v[172:175], v[40:43], v[108:111], 0
    v_mfma_f32_16x16x32_bf16 v[172:175], v[44:47], v[140:143], v[172:175]
    v_pk_add_f32 v[156:157], v[156:157], v[158:159]
    v_add_f32 v25, v156, v157
    v_mfma_f32_16x16x32_bf16 v[176:179], v[40:43], v[112:115], 0
    v_mfma_f32_16x16x32_bf16 v[176:179], v[44:47], v[144:147], v[176:179]
    v_pk_add_f32 v[160:161], v[160:161], v[162:163]
    v_add_f32 v26, v160, v161
    v_mfma_f32_16x16x32_bf16 v[180:183], v[40:43], v[116:119], 0
    v_mfma_f32_16x16x32_bf16 v[180:183], v[44:47], v[148:151], v[180:183]
    v_pk_add_f32 v[164:165], v[164:165], v[166:167]
    v_add_f32 v27, v164, v165
    s_nop 0
    buffer_store_dwordx4 v[24:27], v7, s[40:43], s46 offen sc1
    v_pk_add_f32 v[168:169], v[168:169], v[170:171]
    v_add_f32 v28, v168, v169
    v_pk_add_f32 v[172:173], v[172:173], v[174:175]
    v_add_f32 v29, v172, v173
    v_pk_add_f32 v[176:177], v[176:177], v[178:179]
    v_add_f32 v30, v176, v177
    s_nop 0
    v_pk_add_f32 v[180:181], v[180:181], v[182:183]
    v_add_f32 v31, v180, v181
    s_mov_b64 exec, s[38:39]
    buffer_store_dwordx4 v[28:31], v7, s[40:43], s46 offen offset:256 sc1
    s_mov_b64 exec, -1
    s_endpgm
L_h4:
    v_and_b32 v8, 31, v0
    v_lshlrev_b32 v8, 3, v8
    v_mul_u32_u24 v9, 1792, v3
    v_add_u32 v9, v9, v8
    v_add_u32 v9, 132096, v9
    s_lshl_b32 s56, s31, 10
    s_add_u32 s56, s56, 1114112
    s_lshl_b32 s57, s29, 8
    s_add_u32 s57, s57, s56
    s_add_u32 s62, s62, 1
    v_lshlrev_b32 v5, 4, v0
    v_lshlrev_b32 v11, 3, v0
    v_add_u32 v11, 135680, v11
    s_mov_b32 s63, 1048576
L_poll24:
    ds_read_b32 v6, v14 offset:12
    s_waitcnt lgkmcnt(0)
    v_readfirstlane_b32 s48, v6
    s_cmp_ge_u32 s48, 7
    s_cbranch_scc1 L_go25
    s_sub_u32 s63, s63, 1
    s_cbranch_scc0 L_poll24
L_go25:
    ds_read_b64 v[88:89], v9 offset:0
    ds_read_b64 v[90:91], v9 offset:256
    ds_read_b64 v[92:93], v9 offset:512
    ds_read_b64 v[94:95], v9 offset:768
    ds_read_b64 v[96:97], v9 offset:1024
    ds_read_b64 v[98:99], v9 offset:1280
    ds_read_b64 v[100:101], v9 offset:1536
    s_waitcnt lgkmcnt(5)
    v_pk_add_f32 v[88:89], v[88:89], v[90:91]
    s_waitcnt lgkmcnt(4)
    v_pk_add_f32 v[88:89], v[88:89], v[92:93]
    s_waitcnt lgkmcnt(3)
    v_pk_add_f32 v[88:89], v[88:89], v[94:95]
    s_waitcnt lgkmcnt(2)
    v_pk_add_f32 v[88:89], v[88:89], v[96:97]
    s_waitcnt lgkmcnt(1)
    v_pk_add_f32 v[88:89], v[88:89], v[98:99]
    s_waitcnt lgkmcnt(0)
    v_pk_add_f32 v[88:89], v[88:89], v[100:101]
    v_mov_b32 v90, v88
    v_mov_b32 v91, v89
    s_nop 1
    v_permlane32_swap_b32 v88, v90
    v_permlane32_swap_b32 v89, v91
    v_pk_add_f32 v[88:89], v[88:89], v[90:91]
    v_mov_b32 v7, s62
    v_cvt_pk_bf16_f32 v6, v88, v89
    s_mov_b32 exec_hi, 0
    buffer_store_dwordx2 v[6:7], v8, s[40:43], s57 offen sc1
    s_mov_b32 exec_hi, -1
    s_mov_b32 s63, 131072
L_qpoll:
    buffer_load_dwordx4 v[88:91], v5, s[40:43], s56 offen sc1
    s_waitcnt vmcnt(0)
    v_cmp_ne_u32 vcc, s62, v89
    v_cmp_ne_u32 s[48:49], s62, v91
    s_or_b64 vcc, vcc, s[48:49]
    s_cbranch_scc0 L_qok
    s_sleep 2
    s_sub_u32 s63, s63, 1
    s_cbranch_scc0 L_qpoll
L_qok:
    v_mov_b32 v89, v90
    ds_write_b64 v11, v[88:89]
    v_mov_b32 v6, 1
    s_waitcnt lgkmcnt(0)
    ds_write_b32 v14, v6 offset:24
    s_lshr_b32 s48, s2, 3
    s_and_b32 s49, s2, 7
    s_mul_i32 s50, s49, 4
    s_add_u32 s48, s48, s50
    s_and_b32 s48, s48, 31
    s_lshl_b32 s48, s48, 12
    s_add_u32 s48, s48, 1245184
    s_add_u32 s94, s26, s48
    s_addc_u32 s95, s27, 0
    s_lshr_b32 s50, s2, 8
    s_or_b32 s49, s49, s50
    s_cbranch_scc1 L_nolead
    v_lshlrev_b32 v6, 8, v0
    s_mov_b64 exec, 0xffff
    buffer_store_dword v15, v6, s[40:43], s48 offen sc1
    s_mov_b64 exec, -1
L_nolead:
    s_mov_b32 s63, 1048576
L_poll26:
    ds_read_b32 v6, v14 offset:36
    s_waitcnt lgkmcnt(0)
    v_readfirstlane_b32 s48, v6
    s_cmp_ge_u32 s48, 7
    s_cbranch_scc1 L_go27
    s_sleep 2
    s_sub_u32 s63, s63, 1
    s_cbranch_scc0 L_poll26
L_go27:
    s_getpc_b64 s[52:53]
L_pc28:
    s_add_u32 s52, s52, L_fb-L_pc28
    s_addc_u32 s53, s53, 0
    v_lshlrev_b32 v9, 3, v0
    v_add_u32 v9, 131136, v9
    s_mov_b32 s63, 1048576
L_poll29:
    ds_read_b32 v6, v14 offset:16
    s_waitcnt lgkmcnt(0)
    v_readfirstlane_b32 s48, v6
    s_cmp_ge_u32 s48, 2
    s_cbranch_scc1 L_go30
    s_sleep 8
    s_sub_u32 s63, s63, 1
    s_cbranch_scc0 L_poll29
L_go30:
    s_mov_b64 exec, 3
    ds_read_b64 v[6:7], v9
    s_lshl_b32 s48, s31, 2
    s_add_u32 s48, s48, s29
    s_lshl_b32 s48, s48, 5
    s_add_u32 s48, s48, 1048576
    s_waitcnt lgkmcnt(0)
    v_mov_b32 v40, v6
    v_mov_b32 v41, s62
    v_mov_b32 v42, v7
    v_mov_b32 v43, s62
    buffer_store_dwordx4 v[40:43], v5, s[40:43], s48 offen sc1
    s_mov_b64 exec, -1
    s_mov_b32 s63, 1048576
L_poll31:
    ds_read_b32 v6, v14 offset:0
    s_waitcnt lgkmcnt(0)
    v_readfirstlane_b32 s48, v6
    s_cmp_ge_u32 s48, 144
    s_cbranch_scc1 L_go32
    s_sleep 8
    s_sub_u32 s63, s63, 1
    s_cbranch_scc0 L_poll31
L_go32:
    v_and_b32 v8, 7, v0
    v_lshlrev_b32 v9, 4, v8
    s_lshl_b32 s61, s31, 7
    s_add_u32 s61, s61, 1048576
    s_mov_b32 s63, 131072
L_mlpoll:
    buffer_load_dwordx4 v[44:47], v9, s[40:43], s61 offen sc1
    s_waitcnt vmcnt(0)
    v_cmp_ne_u32 vcc, s62, v45
    v_cmp_ne_u32 s[48:49], s62, v47
    s_or_b64 vcc, vcc, s[48:49]
    s_cbranch_scc0 L_mlgot
    s_sleep 24
    s_sub_u32 s63, s63, 1
    s_cbranch_scc0 L_mlpoll
L_mlgot:
    v_mov_b32 v10, v44
    s_nop 1
    v_max_f32_dpp v10, v10, v10 row_ror:4 row_mask:0xf bank_mask:0xf
    s_nop 1
    v_max_f32_dpp v10, v10, v10 row_ror:2 row_mask:0xf bank_mask:0xf
    s_nop 1
    v_max_f32_dpp v10, v10, v10 row_ror:1 row_mask:0xf bank_mask:0xf
    v_sub_f32 v6, v44, v10
    v_mul_f32 v6, 0x3db8aa3b, v6
    v_exp_f32 v6, v6
    s_nop 0
    v_mul_f32 v7, v6, v46
    s_nop 1
    v_add_f32_dpp v7, v7, v7 row_ror:4 row_mask:0xf bank_mask:0xf
    s_nop 1
    v_add_f32_dpp v7, v7, v7 row_ror:2 row_mask:0xf bank_mask:0xf
    s_nop 1
    v_add_f32_dpp v7, v7, v7 row_ror:1 row_mask:0xf bank_mask:0xf
    v_rcp_f32 v7, v7
    v_lshrrev_b32 v9, 1, v0
    v_and_b32 v8, 1, v0
    v_mul_f32 v6, v6, v7
    v_lshlrev_b32 v8, 2, v8
    v_add_u32 v8, 131152, v8
    v_cmp_eq_u32 vcc, s29, v9
    s_mov_b64 exec, vcc
    ds_write_b32 v8, v6
    s_mov_b64 exec, -1
    s_cmp_lg_u32 s29, 0
    s_cbranch_scc1 L_noadd
    s_mov_b32 s48, 4
    s_atomic_add s48, s[24:25], 0
    s_waitcnt lgkmcnt(0)
L_noadd:
    s_mov_b32 s50, 160
    s_mov_b32 s51, 0x54300221
    s_swappc_b64 s[54:55], s[52:53]
    s_mov_b32 s63, 1048576
L_poll33:
    ds_read_b32 v6, v14 offset:0
    s_waitcnt lgkmcnt(0)
    v_readfirstlane_b32 s48, v6
    s_cmp_ge_u32 s48, 192
    s_cbranch_scc1 L_go34
    s_sleep 8
    s_sub_u32 s63, s63, 1
    s_cbranch_scc0 L_poll33
L_go34:
    s_load_dword s48, s[24:25], 0
    s_waitcnt lgkmcnt(0)
    s_mov_b32 s63, 131072
L_cntpoll:
    s_cmp_ge_u32 s48, 256
    s_cbranch_scc1 L_cntok
    s_sleep 64
    s_mov_b32 s48, 0
    s_atomic_add s48, s[24:25], 0 glc
    s_waitcnt lgkmcnt(0)
    s_sub_u32 s63, s63, 1
    s_cbranch_scc0 L_cntpoll
L_cntok:
    s_cmp_lg_u32 s2, 0
    s_cbranch_scc1 L_noep
    v_mov_b32 v6, s62
    s_mov_b32 s48, 1179648
    s_mov_b64 exec, 1
    buffer_store_dword v6, v15, s[40:43], s48 offen sc1
    s_mov_b64 exec, -1
L_noep:
    v_mov_b32 v6, 1
    s_waitcnt lgkmcnt(0)
    ds_write_b32 v14, v6 offset:20
    s_mov_b32 s50, 200
    s_mov_b32 s51, 0x54300221
    s_swappc_b64 s[54:55], s[52:53]
    s_mov_b32 s50, 224
    s_mov_b32 s51, 0x54300221
    s_swappc_b64 s[54:55], s[52:53]
    s_mov_b32 s50, 242
    s_mov_b32 s51, 0x54300221
    s_swappc_b64 s[54:55], s[52:53]
    s_branch L_done
L_fb:
    s_mov_b32 s63, 1048576
L_poll35:
    ds_read_b32 v6, v14 offset:0
    s_waitcnt lgkmcnt(0)
    v_readfirstlane_b32 s48, v6
    s_cmp_ge_u32 s48, s50
    s_cbranch_scc1 L_go36
    s_sleep 4
    s_sub_u32 s63, s63, 1
    s_cbranch_scc0 L_poll35
L_go36:
    s_mov_b32 s48, 1
    s_atomic_add s48, s[94:95], 0 glc
    s_waitcnt lgkmcnt(0)
    s_min_u32 s48, s48, 7
    s_lshl_b32 s48, s48, 2
    s_lshr_b32 s93, s51, s48
    s_and_b32 s93, s93, 15
    v_mov_b32 v6, s93
    ds_write_b32 v14, v6 offset:28
    s_add_u32 s94, s94, 256
    s_addc_u32 s95, s95, 0
    s_setpc_b64 s[54:55]
L_ffn:
    v_lshlrev_b32 v5, 5, v0
    s_and_b32 s48, s2, 7
    s_mul_i32 s48, s48, 7168
    s_mul_i32 s49, s62, 1792
    s_add_u32 s48, s48, s49
    s_add_u32 s56, s48, 991232
    s_add_u32 s57, s56, 16
    v_lshlrev_b32 v8, 4, v0
    s_mul_i32 s48, s62, 960
    s_add_u32 s48, s48, 145152
    v_add_u32 v8, s48, v8
    v_and_b32 v9, 3, v1
    v_mul_u32_u24 v10, 960, v9
    v_lshl_add_u32 v10, v2, 4, v10
    s_and_b32 s48, s62, 1
    s_mul_i32 s48, s48, 448
    s_add_u32 s48, s48, 145152
    v_add_u32 v10, s48, v10
    v_lshlrev_b32 v11, 6, v9
    v_lshl_add_u32 v11, v2, 4, v11
    v_add_u32 v11, 148992, v11
    s_lshl_b32 s48, s62, 9
    v_add_u32 v12, s48, v11
    v_mul_u32_u24 v13, 100352, v9
    v_bfe_u32 v6, v1, 2, 1
    v_lshl_add_u32 v13, v6, 6, v13
    v_lshl_add_u32 v13, v2, 4, v13
    v_cmp_eq_u32 s[46:47], 0, v6
    v_mov_b32 v7, v13
    v_mov_b32 v4, s91
    s_lshl_b32 s58, s59, 7
    s_mul_i32 s48, s62, 28672
    s_add_u32 s58, s58, s48
    s_add_u32 s58, s58, 458752
    s_mov_b32 s44, -1
    s_mov_b32 s45, 0x00ffffff
    s_mov_b32 s42, 0
    s_mov_b64 vcc, -1
    s_mov_b32 s61, 0
    s_branch L_ffnbody
L_ffnreal:
    s_mov_b32 s42, 3145728
    s_mov_b64 vcc, 0
    s_mov_b64 exec, -1
    v_mov_b32 v13, v7
    s_mov_b32 s63, 1048576
L_poll37:
    ds_read_b32 v6, v14 offset:20
    s_waitcnt lgkmcnt(0)
    v_readfirstlane_b32 s48, v6
    s_cmp_ge_u32 s48, 1
    s_cbranch_scc1 L_go38
    s_sleep 16
    s_sub_u32 s63, s63, 1
    s_cbranch_scc0 L_poll37
L_go38:
    s_cmp_ge_u32 s62, 2
    s_cselect_b32 s32, s18, s16
    s_cselect_b32 s33, s19, s17
    s_and_b32 s33, s33, 0xffff
    s_mov_b32 s34, 1605632
    s_mov_b32 s35, 0x20000
    s_mov_b32 s36, s20
    s_and_b32 s37, s21, 0xffff
    s_mov_b32 s38, 1605632
    s_mov_b32 s39, 0x20000
    v_lshrrev_b32 v24, 2, v0
    v_and_b32 v25, 7, v24
    v_lshrrev_b32 v26, 3, v24
    v_lshl_add_u32 v26, v25, 2, v26
    v_mul_u32_u24 v26, 3584, v26
    v_and_b32 v25, 3, v0
    v_lshl_add_u32 v26, v25, 4, v26
    v_lshrrev_b32 v27, 3, v0
    v_mul_u32_u24 v27, 896, v27
    v_and_b32 v25, 7, v0
    v_lshl_add_u32 v27, v25, 4, v27
    s_mul_i32 s51, s62, 20480
    v_lshrrev_b32 v28, 2, v1
    v_and_b32 v29, 3, v1
    v_lshlrev_b32 v29, 3, v29
    v_lshl_add_u32 v30, v2, 3, v28
    v_lshl_add_u32 v30, v30, 6, v29
    v_add_u32 v30, s51, v30
    v_lshl_add_u32 v31, v2, 2, v28
    v_lshl_add_u32 v31, v31, 7, v29
    s_lshl_b32 s49, s62, 11
    s_add_u32 s60, s49, 151040
    v_add_u32 v28, s60, v31
    v_add_u32 v31, s51, v31
    s_and_b32 s48, s62, 1
    s_mul_i32 s92, s48, 802816
    s_lshl_b32 s49, s59, 6
    s_add_u32 s92, s92, s49
    s_mul_i32 s93, s59, 28672
    s_lshl_b32 s49, s62, 8
    s_add_u32 s93, s93, s49
    s_mov_b32 s63, 1048576
L_poll39:
    ds_read_b32 v6, v14 offset:40
    s_waitcnt lgkmcnt(0)
    v_readfirstlane_b32 s48, v6
    s_cmp_ge_u32 s48, 1
    s_cbranch_scc1 L_go40
    s_sleep 2
    s_sub_u32 s63, s63, 1
    s_cbranch_scc0 L_poll39
L_go40:
    s_add_u32 m0, s51, 0
    s_add_u32 s48, s92, 344064
    buffer_load_dwordx4 v26, s[32:35], s48 offen nt lds
    s_add_u32 m0, s51, 1024
    s_add_u32 s48, s92, 351232
    buffer_load_dwordx4 v26, s[32:35], s48 offen nt lds
    s_add_u32 m0, s51, 2048
    s_add_u32 s48, s92, 458752
    buffer_load_dwordx4 v26, s[32:35], s48 offen nt lds
    s_add_u32 m0, s51, 3072
    s_add_u32 s48, s92, 465920
    buffer_load_dwordx4 v26, s[32:35], s48 offen nt lds
    s_add_u32 m0, s51, 4096
    s_add_u32 s48, s92, 573440
    buffer_load_dwordx4 v26, s[32:35], s48 offen nt lds
    s_add_u32 m0, s51, 5120
    s_add_u32 s48, s92, 580608
    buffer_load_dwordx4 v26, s[32:35], s48 offen nt lds
    s_add_u32 m0, s51, 6144
    s_add_u32 s48, s92, 688128
    buffer_load_dwordx4 v26, s[32:35], s48 offen nt lds
    s_add_u32 m0, s51, 7168
    s_add_u32 s48, s92, 695296
    buffer_load_dwordx4 v26, s[32:35], s48 offen nt lds
    s_add_u32 m0, s51, 12288
    s_add_u32 s48, s93, 0
    buffer_load_dwordx4 v27, s[36:39], s48 offen nt lds
    s_add_u32 m0, s51, 13312
    s_add_u32 s48, s93, 7168
    buffer_load_dwordx4 v27, s[36:39], s48 offen nt lds
    s_add_u32 m0, s51, 14336
    s_add_u32 s48, s93, 14336
    buffer_load_dwordx4 v27, s[36:39], s48 offen nt lds
    s_add_u32 m0, s51, 15360
    s_add_u32 s48, s93, 21504
    buffer_load_dwordx4 v27, s[36:39], s48 offen nt lds
    s_add_u32 m0, s51, 16384
    s_add_u32 s48, s93, 128
    buffer_load_dwordx4 v27, s[36:39], s48 offen nt lds
    s_add_u32 m0, s51, 17408
    s_add_u32 s48, s93, 7296
    buffer_load_dwordx4 v27, s[36:39], s48 offen nt lds
    s_add_u32 m0, s51, 18432
    s_add_u32 s48, s93, 14464
    buffer_load_dwordx4 v27, s[36:39], s48 offen nt lds
    s_add_u32 m0, s51, 19456
    s_add_u32 s48, s93, 21632
    buffer_load_dwordx4 v27, s[36:39], s48 offen nt lds
    s_waitcnt vmcnt(14)
    ds_read_b64_tr_b16 v[208:209], v30 offset:0
    ds_read_b64_tr_b16 v[210:211], v30 offset:256
    ds_read_b64_tr_b16 v[212:213], v30 offset:32
    ds_read_b64_tr_b16 v[214:215], v30 offset:288
    s_waitcnt lgkmcnt(4)
    s_waitcnt vmcnt(12)
    ds_read_b64_tr_b16 v[216:217], v30 offset:2048
    ds_read_b64_tr_b16 v[218:219], v30 offset:2304
    ds_read_b64_tr_b16 v[220:221], v30 offset:2080
    ds_read_b64_tr_b16 v[222:223], v30 offset:2336
    s_waitcnt vmcnt(10)
    ds_read_b64_tr_b16 v[224:225], v30 offset:4096
    ds_read_b64_tr_b16 v[226:227], v30 offset:4352
    ds_read_b64_tr_b16 v[228:229], v30 offset:4128
    ds_read_b64_tr_b16 v[230:231], v30 offset:4384
    s_waitcnt lgkmcnt(4)
    s_waitcnt vmcnt(8)
    ds_read_b64_tr_b16 v[232:233], v30 offset:6144
    ds_read_b64_tr_b16 v[234:235], v30 offset:6400
    ds_read_b64_tr_b16 v[236:237], v30 offset:6176
    ds_read_b64_tr_b16 v[238:239], v30 offset:6432
    s_waitcnt vmcnt(4)
    ds_read_b64_tr_b16 v[56:57], v31 offset:12288
    ds_read_b64_tr_b16 v[58:59], v31 offset:14336
    ds_read_b64_tr_b16 v[60:61], v31 offset:12320
    ds_read_b64_tr_b16 v[62:63], v31 offset:14368
    s_waitcnt lgkmcnt(4)
    ds_read_b64_tr_b16 v[64:65], v31 offset:12352
    ds_read_b64_tr_b16 v[66:67], v31 offset:14400
    ds_read_b64_tr_b16 v[68:69], v31 offset:12384
    ds_read_b64_tr_b16 v[70:71], v31 offset:14432
    s_waitcnt lgkmcnt(4)
    s_waitcnt vmcnt(0)
    ds_read_b64_tr_b16 v[72:73], v31 offset:16384
    ds_read_b64_tr_b16 v[74:75], v31 offset:18432
    ds_read_b64_tr_b16 v[76:77], v31 offset:16416
    ds_read_b64_tr_b16 v[78:79], v31 offset:18464
    s_waitcnt lgkmcnt(4)
    ds_read_b64_tr_b16 v[80:81], v31 offset:16448
    ds_read_b64_tr_b16 v[82:83], v31 offset:18496
    ds_read_b64_tr_b16 v[84:85], v31 offset:16480
    ds_read_b64_tr_b16 v[86:87], v31 offset:18528
    s_waitcnt lgkmcnt(4)
    s_waitcnt lgkmcnt(0)
    s_lshl_b32 s61, s2, 7
    s_add_u32 s61, s61, 1212416
    s_mov_b64 exec, s[44:45]
    buffer_load_dwordx4 v[152:155], v5, s[40:43], s56 offen sc1
    buffer_load_dwordx4 v[156:159], v5, s[40:43], s57 offen sc1
    s_mov_b32 s63, 131072
L_gp41:
    s_mov_b64 exec, s[44:45]
    s_waitcnt vmcnt(1)
    v_max3_u32 v6, v152, v153, v154
    v_max_u32 v6, v6, v155
    v_cmp_eq_u32 s[80:81], -1, v6
    s_waitcnt vmcnt(0)
    v_max3_u32 v6, v156, v157, v158
    v_max_u32 v6, v6, v159
    v_cmp_eq_u32 s[82:83], -1, v6
    s_or_b64 s[50:51], s[80:81], s[82:83]
    s_cbranch_scc0 L_gg42
    s_or_b64 exec, s[80:81], 1
    buffer_load_dwordx4 v[152:155], v5, s[40:43], s56 offen sc1
    s_or_b64 exec, s[82:83], 1
    buffer_load_dwordx4 v[156:159], v5, s[40:43], s57 offen sc1
    s_sub_u32 s63, s63, 1
    s_cbranch_scc0 L_gp41
L_gg42:
    s_mov_b64 exec, -1
L_ffnbody:
    v_readfirstlane_b32 s48, v152
    v_mov_b32 v96, 0
    v_mov_b32 v98, 0
    s_mov_b32 exec_hi, 0x00ffffff
    v_pk_add_f32 v[88:89], v[152:153], s[48:49] op_sel_hi:[1,0] neg_lo:[0,1] neg_hi:[0,1]
    v_pk_add_f32 v[90:91], v[154:155], s[48:49] op_sel_hi:[1,0] neg_lo:[0,1] neg_hi:[0,1]
    v_pk_add_f32 v[92:93], v[156:157], s[48:49] op_sel_hi:[1,0] neg_lo:[0,1] neg_hi:[0,1]
    v_pk_add_f32 v[94:95], v[158:159], s[48:49] op_sel_hi:[1,0] neg_lo:[0,1] neg_hi:[0,1]
    v_pk_add_f32 v[100:101], v[88:89], v[90:91]
    v_pk_mul_f32 v[98:99], v[88:89], v[88:89]
    v_pk_add_f32 v[96:97], v[92:93], v[94:95]
    v_pk_fma_f32 v[98:99], v[90:91], v[90:91], v[98:99]
    v_pk_add_f32 v[96:97], v[96:97], v[100:101]
    v_pk_fma_f32 v[98:99], v[92:93], v[92:93], v[98:99]
    v_add_f32 v96, v96, v97
    v_pk_fma_f32 v[98:99], v[94:95], v[94:95], v[98:99]
    s_mov_b32 s49, 0x3b124925
    v_add_f32 v98, v98, v99
    s_mov_b32 exec_hi, -1
    s_nop 0
    v_add_f32_dpp v96, v96, v96 row_ror:8 row_mask:0xf bank_mask:0xf
    v_add_f32_dpp v98, v98, v98 row_ror:8 row_mask:0xf bank_mask:0xf
    s_nop 0
    v_add_f32_dpp v96, v96, v96 row_ror:4 row_mask:0xf bank_mask:0xf
    v_add_f32_dpp v98, v98, v98 row_ror:4 row_mask:0xf bank_mask:0xf
    s_nop 0
    v_add_f32_dpp v96, v96, v96 row_ror:2 row_mask:0xf bank_mask:0xf
    v_add_f32_dpp v98, v98, v98 row_ror:2 row_mask:0xf bank_mask:0xf
    s_nop 0
    v_add_f32_dpp v96, v96, v96 row_ror:1 row_mask:0xf bank_mask:0xf
    v_add_f32_dpp v98, v98, v98 row_ror:1 row_mask:0xf bank_mask:0xf
    s_nop 0
    v_add_f32_dpp v96, v96, v96 row_bcast:15 row_mask:0xa bank_mask:0xf
    v_add_f32_dpp v98, v98, v98 row_bcast:15 row_mask:0xa bank_mask:0xf
    s_nop 0
    v_add_f32_dpp v96, v96, v96 row_bcast:31 row_mask:0xc bank_mask:0xf
    v_add_f32_dpp v98, v98, v98 row_bcast:31 row_mask:0xc bank_mask:0xf
    v_mov_b32 v100, s49
    v_readlane_b32 s50, v96, 63
    v_readlane_b32 s51, v98, 63
    s_nop 0
    v_mul_f32 v96, s50, v100
    v_mul_f32 v98, s51, v100
    v_add_f32 v100, s48, v96
    v_fma_f32 v98, -v96, v96, v98
    v_cvt_pk_bf16_f32 v100, v100, v100
    v_max_f32 v98, 0, v98
    v_and_b32 v100, 0xffff0000, v100
    v_cvt_pk_bf16_f32 v98, v98, v98
    v_pk_add_f32 v[88:89], v[152:153], v[100:101] op_sel_hi:[1,0] neg_lo:[0,1] neg_hi:[0,1]
    v_and_b32 v98, 0xffff0000, v98
    v_pk_add_f32 v[90:91], v[154:155], v[100:101] op_sel_hi:[1,0] neg_lo:[0,1] neg_hi:[0,1]
    v_add_f32 v98, 0x3727c5ac, v98
    v_pk_add_f32 v[92:93], v[156:157], v[100:101] op_sel_hi:[1,0] neg_lo:[0,1] neg_hi:[0,1]
    v_cvt_pk_bf16_f32 v98, v98, v98
    v_pk_add_f32 v[94:95], v[158:159], v[100:101] op_sel_hi:[1,0] neg_lo:[0,1] neg_hi:[0,1]
    v_and_b32 v98, 0xffff0000, v98
    v_cvt_pk_bf16_f32 v40, v88, v89
    v_sqrt_f32 v98, v98
    v_cvt_pk_bf16_f32 v41, v90, v91
    v_cvt_pk_bf16_f32 v98, v98, v98
    v_cvt_pk_bf16_f32 v42, v92, v93
    v_and_b32 v98, 0xffff0000, v98
    v_cvt_pk_bf16_f32 v43, v94, v95
    v_rcp_f32 v98, v98
    v_lshlrev_b32 v88, 16, v40
    v_and_b32 v89, 0xffff0000, v40
    v_lshlrev_b32 v90, 16, v41
    v_and_b32 v91, 0xffff0000, v41
    v_lshlrev_b32 v92, 16, v42
    v_and_b32 v93, 0xffff0000, v42
    v_lshlrev_b32 v94, 16, v43
    v_and_b32 v95, 0xffff0000, v43
    v_pk_mul_f32 v[88:89], v[88:89], v[98:99] op_sel_hi:[1,0]
    v_pk_mul_f32 v[90:91], v[90:91], v[98:99] op_sel_hi:[1,0]
    v_pk_mul_f32 v[92:93], v[92:93], v[98:99] op_sel_hi:[1,0]
    v_pk_mul_f32 v[94:95], v[94:95], v[98:99] op_sel_hi:[1,0]
    v_cvt_pk_bf16_f32 v40, v88, v89
    v_cvt_pk_bf16_f32 v41, v90, v91
    v_cvt_pk_bf16_f32 v42, v92, v93
    v_cvt_pk_bf16_f32 v43, v94, v95
    s_mov_b32 exec_hi, 0x00ffffff
    ds_write_b128 v8, v[40:43]
    s_mov_b32 exec_hi, -1
    s_waitcnt lgkmcnt(0)
    s_cbranch_vccnz L_nb1x
    s_barrier
L_nb1x:
    ds_read_b128 v[88:91], v10 offset:0
    ds_read_b128 v[92:95], v10 offset:64
    ds_read_b128 v[96:99], v10 offset:128
    ds_read_b128 v[100:103], v10 offset:192
    ds_read_b128 v[104:107], v10 offset:256
    ds_read_b128 v[108:111], v10 offset:320
    ds_read_b128 v[112:115], v10 offset:384
    s_waitcnt lgkmcnt(6)
    v_mfma_f32_16x16x32_bf16 v[32:35], v[184:187], v[88:91], 0
    v_mfma_f32_16x16x32_bf16 v[36:39], v[188:191], v[88:91], 0
    s_waitcnt lgkmcnt(5)
    v_mfma_f32_16x16x32_bf16 v[32:35], v[192:195], v[92:95], v[32:35]
    v_mfma_f32_16x16x32_bf16 v[36:39], v[196:199], v[92:95], v[36:39]
    s_waitcnt lgkmcnt(4)
    v_mfma_f32_16x16x32_bf16 v[32:35], v[200:203], v[96:99], v[32:35]
    v_mfma_f32_16x16x32_bf16 v[36:39], v[204:207], v[96:99], v[36:39]
    s_waitcnt lgkmcnt(3)
    v_mfma_f32_16x16x32_bf16 v[32:35], v[208:211], v[100:103], v[32:35]
    v_mfma_f32_16x16x32_bf16 v[36:39], v[212:215], v[100:103], v[36:39]
    s_waitcnt lgkmcnt(2)
    v_mfma_f32_16x16x32_bf16 v[32:35], v[216:219], v[104:107], v[32:35]
    v_mfma_f32_16x16x32_bf16 v[36:39], v[220:223], v[104:107], v[36:39]
    s_waitcnt lgkmcnt(1)
    v_mfma_f32_16x16x32_bf16 v[32:35], v[224:227], v[108:111], v[32:35]
    v_mfma_f32_16x16x32_bf16 v[36:39], v[228:231], v[108:111], v[36:39]
    s_waitcnt lgkmcnt(0)
    v_mfma_f32_16x16x32_bf16 v[32:35], v[232:235], v[112:115], v[32:35]
    v_mfma_f32_16x16x32_bf16 v[36:39], v[236:239], v[112:115], v[36:39]
    s_nop 6
    ds_write_b128 v12, v[32:35]
    ds_write_b128 v12, v[36:39] offset:256
    s_waitcnt lgkmcnt(0)
    s_cbranch_vccnz L_nb2x
    s_barrier
L_nb2x:
    ds_read_b128 v[88:91], v11 offset:0
    ds_read_b128 v[92:95], v11 offset:512
    ds_read_b128 v[96:99], v11 offset:1024
    ds_read_b128 v[100:103], v11 offset:1536
    ds_read_b128 v[104:107], v11 offset:256
    ds_read_b128 v[108:111], v11 offset:768
    ds_read_b128 v[112:115], v11 offset:1280
    ds_read_b128 v[116:119], v11 offset:1792
    s_waitcnt lgkmcnt(6)
    v_pk_add_f32 v[88:89], v[88:89], v[92:93]
    v_pk_add_f32 v[90:91], v[90:91], v[94:95]
    s_waitcnt lgkmcnt(4)
    v_pk_add_f32 v[96:97], v[96:97], v[100:101]
    v_pk_add_f32 v[98:99], v[98:99], v[102:103]
    v_cvt_pk_bf16_f32 v92, v88, v96
    v_cvt_pk_bf16_f32 v93, v89, v97
    v_cvt_pk_bf16_f32 v94, v90, v98
    v_cvt_pk_bf16_f32 v95, v91, v99
    v_lshlrev_b32 v88, 16, v92
    v_and_b32 v92, 0xffff0000, v92
    v_lshlrev_b32 v89, 16, v93
    v_and_b32 v93, 0xffff0000, v93
    v_lshlrev_b32 v90, 16, v94
    v_and_b32 v94, 0xffff0000, v94
    v_lshlrev_b32 v91, 16, v95
    v_and_b32 v95, 0xffff0000, v95
    v_pk_mul_f32 v[88:89], v[88:89], v[92:93]
    v_pk_mul_f32 v[90:91], v[90:91], v[94:95]
    v_cvt_pk_bf16_f32 v40, v88, v89
    v_cvt_pk_bf16_f32 v41, v90, v91
    s_waitcnt lgkmcnt(2)
    v_pk_add_f32 v[104:105], v[104:105], v[108:109]
    v_pk_add_f32 v[106:107], v[106:107], v[110:111]
    s_waitcnt lgkmcnt(0)
    v_pk_add_f32 v[112:113], v[112:113], v[116:117]
    v_pk_add_f32 v[114:115], v[114:115], v[118:119]
    v_cvt_pk_bf16_f32 v108, v104, v112
    v_cvt_pk_bf16_f32 v109, v105, v113
    v_cvt_pk_bf16_f32 v110, v106, v114
    v_cvt_pk_bf16_f32 v111, v107, v115
    v_lshlrev_b32 v104, 16, v108
    v_and_b32 v108, 0xffff0000, v108
    v_lshlrev_b32 v105, 16, v109
    v_and_b32 v109, 0xffff0000, v109
    v_lshlrev_b32 v106, 16, v110
    v_and_b32 v110, 0xffff0000, v110
    v_lshlrev_b32 v107, 16, v111
    v_and_b32 v111, 0xffff0000, v111
    v_pk_mul_f32 v[104:105], v[104:105], v[108:109]
    v_pk_mul_f32 v[106:107], v[106:107], v[110:111]
    v_cvt_pk_bf16_f32 v42, v104, v105
    v_cvt_pk_bf16_f32 v43, v106, v107
    s_cmp_lg_u32 s62, 3
    s_cbranch_scc1 L_nofl
    s_mov_b64 exec, 1
    buffer_store_dword v4, v15, s[40:43], s61 offen sc1
    s_mov_b64 exec, -1
L_nofl:
    v_cndmask_b32 v44, 0, v40, s[46:47]
    v_cndmask_b32 v45, 0, v41, s[46:47]
    v_cndmask_b32 v46, 0, v42, s[46:47]
    v_cndmask_b32 v47, 0, v43, s[46:47]
    v_cndmask_b32 v48, v40, 0, s[46:47]
    v_cndmask_b32 v49, v41, 0, s[46:47]
    v_cndmask_b32 v50, v42, 0, s[46:47]
    v_cndmask_b32 v51, v43, 0, s[46:47]
    v_mfma_f32_16x16x32_bf16 v[88:91], v[56:59], v[44:47], 0
    s_nop 0
    v_mfma_f32_16x16x32_bf16 v[92:95], v[64:67], v[44:47], 0
    v_mfma_f32_16x16x32_bf16 v[96:99], v[72:75], v[44:47], 0
    v_mfma_f32_16x16x32_bf16 v[100:103], v[80:83], v[44:47], 0
    v_mfma_f32_16x16x32_bf16 v[88:91], v[60:63], v[48:51], v[88:91]
    v_mfma_f32_16x16x32_bf16 v[92:95], v[68:71], v[48:51], v[92:95]
    v_mfma_f32_16x16x32_bf16 v[96:99], v[76:79], v[48:51], v[96:99]
    v_mfma_f32_16x16x32_bf16 v[100:103], v[84:87], v[48:51], v[100:103]
    s_mov_b32 exec_lo, 0x00ff00ff
    s_mov_b32 exec_hi, 0x00ff00ff
    s_cmp_eq_u32 s62, 3
    s_nop 1
    buffer_store_dwordx4 v[88:91], v13, s[40:43], s58 offen sc1
    v_add_u32 v13, 7168, v13
    buffer_store_dwordx4 v[92:95], v13, s[40:43], s58 offen sc1
    v_add_u32 v13, 7168, v13
    s_cbranch_scc1 L_opdone
    buffer_store_dwordx4 v[96:99], v13, s[40:43], s58 offen sc1
    v_add_u32 v13, 7168, v13
    buffer_store_dwordx4 v[100:103], v13, s[40:43], s58 offen sc1
L_opdone:
    s_cbranch_vccnz L_ffnreal
    s_mov_b64 exec, -1
    s_branch L_done
L_r1:
    s_sub_u32 s48, s2, 120
    s_cmp_lt_u32 s48, 56
    s_cbranch_scc0 L_done
    s_mul_i32 s58, s48, 4682
    s_lshr_b32 s58, s58, 16
    s_mul_i32 s49, s58, 14
    s_sub_u32 s59, s48, s49
    s_lshl_b32 s56, s48, 7
    v_lshrrev_b32 v5, 3, v0
    v_and_b32 v6, 7, v0
    v_lshlrev_b32 v9, 4, v6
    v_mul_u32_u24 v7, 1792, v5
    v_add_u32 v7, v7, v9
    v_lshl_add_u32 v8, v5, 7, v9
    v_lshl_add_u32 v10, v2, 3, v6
    v_lshlrev_b32 v10, 4, v10
    s_lshl_b32 s49, s62, 2
    s_add_u32 s49, s49, 141312
    v_add_u32 v10, s49, v10
    v_and_b32 v4, 31, v0
    v_lshlrev_b32 v9, 4, v4
    v_add_u32 v9, 141312, v9
    v_lshrrev_b32 v12, 3, v4
    v_lshl_add_u32 v12, v6, 2, v12
    v_lshlrev_b32 v12, 1, v12
    s_lshr_b32 s61, s56, 1
    buffer_load_ushort v11, v12, s[32:35], s61 offen
    v_mul_u32_u24 v13, 7168, v3
    v_lshl_add_u32 v13, v4, 2, v13
    s_mul_i32 s57, s62, 14336
    s_add_u32 s57, s57, s56
    s_add_u32 s57, s57, 991232
    s_mul_i32 s44, s58, 114688
    s_lshl_b32 s49, s59, 7
    s_add_u32 s44, s44, s49
    s_mul_i32 s49, s62, 28672
    s_add_u32 s44, s44, s49
    s_add_u32 s45, s44, 14336
    s_mul_i32 s46, s48, 7168
    s_mul_i32 s49, s62, 1792
    s_add_u32 s46, s46, s49
    s_add_u32 s46, s46, 458752
    s_add_u32 s47, s46, 1024
    s_lshl_b32 s60, s48, 7
    s_add_u32 s60, s60, 1212416
    s_mov_b32 s36, -1
    s_mov_b32 s37, 0xffff
    v_mov_b32 v92, 0
    v_mov_b32 v93, 0
    v_mov_b32 v94, 0
    v_mov_b32 v95, 0
    s_waitcnt vmcnt(0)
    v_lshlrev_b32 v11, 16, v11
    s_mov_b32 s32, s22
    s_and_b32 s33, s23, 0xffff
    s_mov_b32 s34, 3584
    s_mov_b32 s35, 0x20000
    s_mov_b32 s63, 1048576
L_poll43:
    ds_read_b32 v6, v14 offset:20
    s_waitcnt lgkmcnt(0)
    v_readfirstlane_b32 s48, v6
    s_cmp_ge_u32 s48, 1
    s_cbranch_scc1 L_go44
    s_sleep 16
    s_sub_u32 s63, s63, 1
    s_cbranch_scc0 L_poll43
L_go44:
    s_mov_b32 s63, 1048576
L_poll45:
    ds_read_b32 v6, v14 offset:32
    s_waitcnt lgkmcnt(0)
    v_readfirstlane_b32 s48, v6
    s_cmp_ge_u32 s48, 1
    s_cbranch_scc1 L_go46
    s_sleep 4
    s_sub_u32 s63, s63, 1
    s_cbranch_scc0 L_poll45
L_go46:
    s_mov_b64 exec, -1
    buffer_load_dwordx4 v[152:155], v7, s[40:43], s44 offen sc1
    buffer_load_dwordx4 v[156:159], v7, s[40:43], s45 offen sc1
    s_mov_b64 exec, -1
    s_waitcnt vmcnt(1)
    v_max3_u32 v6, v152, v153, v154
    v_max_u32 v6, v6, v155
    v_cmp_eq_u32 s[80:81], -1, v6
    s_waitcnt vmcnt(0)
    v_max3_u32 v6, v156, v157, v158
    v_max_u32 v6, v6, v159
    v_cmp_eq_u32 s[82:83], -1, v6
    s_or_b64 s[50:51], s[80:81], s[82:83]
    s_cbranch_scc0 L_gg48
    s_or_b64 exec, s[80:81], 1
    buffer_load_dwordx4 v[152:155], v7, s[40:43], s44 offen sc1
    s_or_b64 exec, s[82:83], 1
    buffer_load_dwordx4 v[156:159], v7, s[40:43], s45 offen sc1
    s_sleep 5
    s_or_b64 exec, s[80:81], 1
    buffer_load_dwordx4 v[152:155], v7, s[40:43], s44 offen sc1
    s_or_b64 exec, s[82:83], 1
    buffer_load_dwordx4 v[156:159], v7, s[40:43], s45 offen sc1
    s_mov_b32 s63, 131072
L_gp47:
    s_mov_b64 exec, -1
    s_waitcnt vmcnt(3)
    v_max3_u32 v6, v152, v153, v154
    v_max_u32 v6, v6, v155
    v_cmp_eq_u32 s[80:81], -1, v6
    s_waitcnt vmcnt(2)
    v_max3_u32 v6, v156, v157, v158
    v_max_u32 v6, v6, v159
    v_cmp_eq_u32 s[82:83], -1, v6
    s_or_b64 s[50:51], s[80:81], s[82:83]
    s_cbranch_scc0 L_gg48
    s_or_b64 exec, s[80:81], 1
    buffer_load_dwordx4 v[152:155], v7, s[40:43], s44 offen sc1
    s_or_b64 exec, s[82:83], 1
    buffer_load_dwordx4 v[156:159], v7, s[40:43], s45 offen sc1
    s_sub_u32 s63, s63, 1
    s_cbranch_scc0 L_gp47
L_gg48:
    s_mov_b64 exec, -1
L_r1body:
    v_pk_add_f32 v[40:41], v[152:153], v[156:157]
    v_pk_add_f32 v[42:43], v[154:155], v[158:159]
    s_nop 1
    v_permlane16_swap_b32 v40, v41
    v_permlane16_swap_b32 v42, v43
    v_add_f32 v40, v40, v41
    v_add_f32 v42, v42, v43
    s_nop 1
    v_permlane32_swap_b32 v40, v42
    v_add_f32 v40, v40, v42
    s_nop 1
    v_add_f32_dpp v40, v40, v40 row_ror:8 row_mask:0xf bank_mask:0xf
    ds_write_b32 v10, v40 offset:0
    s_waitcnt lgkmcnt(0)
    s_barrier
L_rb0:
    ds_read_b128 v[40:43], v9 offset:0
    s_waitcnt lgkmcnt(0)
    v_pk_add_f32 v[40:41], v[40:41], v[42:43]
    v_add_f32 v40, v40, v41
    v_cvt_pk_bf16_f32 v40, v40, v40
    v_and_b32 v40, 0xffff0000, v40
    v_add_f32 v11, v11, v40
    v_cvt_pk_bf16_f32 v11, v11, v11
    v_and_b32 v11, 0xffff0000, v11
    buffer_store_dword v11, v13, s[40:43], s57 offen sc1
    s_mov_b32 s63, 131072
    s_mov_b64 exec, 0x1
L_wp49:
    buffer_load_dword v6, v15, s[40:43], s60 offen sc1
    s_waitcnt vmcnt(0)
    v_cmp_eq_u32 s[50:51], s91, v6
    s_bcnt1_i32_b64 s48, s[50:51]
    s_cmp_ge_u32 s48, 1
    s_cbranch_scc1 L_wg50
    s_sub_u32 s63, s63, 1
    s_cbranch_scc0 L_wp49
L_wg50:
    s_mov_b64 exec, -1
    s_mov_b64 exec, -1
    buffer_load_dwordx4 v[88:91], v8, s[40:43], s46 offen sc1
    s_mov_b64 exec, s[36:37]
    buffer_load_dwordx4 v[92:95], v8, s[40:43], s47 offen sc1
    s_mov_b64 exec, -1
    s_waitcnt vmcnt(1)
    v_max3_u32 v6, v88, v89, v90
    v_max_u32 v6, v6, v91
    v_cmp_eq_u32 s[80:81], -1, v6
    s_mov_b64 exec, s[36:37]
    s_waitcnt vmcnt(0)
    v_max3_u32 v6, v92, v93, v94
    v_max_u32 v6, v6, v95
    v_cmp_eq_u32 s[82:83], -1, v6
    s_or_b64 s[50:51], s[80:81], s[82:83]
    s_cbranch_scc0 L_gg52
    s_or_b64 exec, s[80:81], 1
    buffer_load_dwordx4 v[88:91], v8, s[40:43], s46 offen sc1
    s_or_b64 exec, s[82:83], 1
    buffer_load_dwordx4 v[92:95], v8, s[40:43], s47 offen sc1
    s_sleep 5
    s_or_b64 exec, s[80:81], 1
    buffer_load_dwordx4 v[88:91], v8, s[40:43], s46 offen sc1
    s_or_b64 exec, s[82:83], 1
    buffer_load_dwordx4 v[92:95], v8, s[40:43], s47 offen sc1
    s_mov_b32 s63, 131072
L_gp51:
    s_mov_b64 exec, -1
    s_waitcnt vmcnt(3)
    v_max3_u32 v6, v88, v89, v90
    v_max_u32 v6, v6, v91
    v_cmp_eq_u32 s[80:81], -1, v6
    s_mov_b64 exec, s[36:37]
    s_waitcnt vmcnt(2)
    v_max3_u32 v6, v92, v93, v94
    v_max_u32 v6, v6, v95
    v_cmp_eq_u32 s[82:83], -1, v6
    s_or_b64 s[50:51], s[80:81], s[82:83]
    s_cbranch_scc0 L_gg52
    s_or_b64 exec, s[80:81], 1
    buffer_load_dwordx4 v[88:91], v8, s[40:43], s46 offen sc1
    s_or_b64 exec, s[82:83], 1
    buffer_load_dwordx4 v[92:95], v8, s[40:43], s47 offen sc1
    s_sub_u32 s63, s63, 1
    s_cbranch_scc0 L_gp51
L_gg52:
    s_mov_b64 exec, -1
L_r3body:
    v_pk_add_f32 v[40:41], v[88:89], v[92:93]
    v_pk_add_f32 v[42:43], v[90:91], v[94:95]
    s_nop 1
    v_permlane16_swap_b32 v40, v41
    v_permlane16_swap_b32 v42, v43
    v_add_f32 v40, v40, v41
    v_add_f32 v42, v42, v43
    s_nop 1
    v_permlane32_swap_b32 v40, v42
    v_add_f32 v40, v40, v42
    s_nop 1
    v_add_f32_dpp v40, v40, v40 row_ror:8 row_mask:0xf bank_mask:0xf
    ds_write_b32 v10, v40 offset:512
    s_waitcnt lgkmcnt(0)
    s_barrier
L_rb512:
    ds_read_b128 v[40:43], v9 offset:512
    s_waitcnt lgkmcnt(0)
    v_pk_add_f32 v[40:41], v[40:41], v[42:43]
    v_add_f32 v40, v40, v41
    v_cvt_pk_bf16_f32 v40, v40, v40
    v_and_b32 v40, 0xffff0000, v40
    v_add_f32 v11, v11, v40
    v_cvt_pk_bf16_f32 v11, v11, v11
    s_lshl_b32 s48, s62, 3
    s_lshl_b32 exec_lo, 0xff, s48
    s_mov_b32 exec_hi, 0
    buffer_store_short v11, v12, s[32:35], s61 offen
    s_mov_b64 exec, -1
L_done:
    s_endpgm
L_exit:
    s_endpgm
.section .rodata,"a"
.p2align 6
.amdhsa_kernel sequential_preLN__mha_block_cached__glu_gated_bilinear__decode_kernel
  .amdhsa_next_free_vgpr 240
  .amdhsa_next_free_sgpr 100
  .amdhsa_accum_offset 240
  .amdhsa_group_segment_fixed_size 0
  .amdhsa_kernarg_size 96
  .amdhsa_user_sgpr_count 2
  .amdhsa_user_sgpr_kernarg_segment_ptr 1
  .amdhsa_system_sgpr_workgroup_id_x 1
  .amdhsa_float_denorm_mode_32 3
.end_amdhsa_kernel
```
